```python
import torch

def _softmax(x, axis=-1):
    return torch.softmax(x, dim=axis)
def _gelu(x):
    return torch.nn.functional.gelu(x, approximate="tanh")
def _silu(x):
    return torch.nn.functional.silu(x)
def _sigmoid(x):
    return torch.sigmoid(x)
def _layernorm(x, axis=-1, eps=1e-5):
    m = x.mean(dim=axis, keepdim=True)
    v = x.var(dim=axis, keepdim=True, unbiased=False)
    return (x - m) / torch.sqrt(v + eps)
def _scatter_add(tgt, idx, src, axis=0):
    return tgt.clone().index_add_(axis, idx, src)
def _segment_sum(src, seg, n):
    out = torch.zeros((n,) + src.shape[1:], dtype=src.dtype)
    return out.index_add_(0, seg, src)
def _pad(x, pw):
    flat = tuple(v for pair in reversed(pw) for v in pair)
    return torch.nn.functional.pad(x, flat)

kernel_name = 'interleave_layers__softmax_full_mha__glu_gated_reglu__prompt'

def setup_inputs():

    _w = (lambda a: (lambda t: t.to(torch.bfloat16) if t.is_floating_point() else t)(torch.as_tensor(a)))
    def _A_setup():
        B, S, D = 1, 2048, 512
        return {
            "x": _w((lambda *s: torch.randn(*s, dtype=torch.bfloat16) * 0.05)(B, S, D)),
            "wqkv": _w((lambda *s: torch.randn(*s, dtype=torch.bfloat16) * 0.05)(D, 3 * D)),
            "wo": _w((lambda *s: torch.randn(*s, dtype=torch.bfloat16) * 0.05)(D, D)),
        }
    _A_in = _A_setup()

    def _B_setup():
        B, S, D, F = 1, 2048, 512, 1792
        return {
            "x": _w((lambda *s: torch.randn(*s, dtype=torch.bfloat16) * 0.05)(B, S, D)),
            "W_gate": _w((lambda *s: torch.randn(*s, dtype=torch.bfloat16) * 0.4)(D, F) * (2.0 / D) ** 0.5),
            "W_up": _w((lambda *s: torch.randn(*s, dtype=torch.bfloat16) * 0.4)(D, F) * (2.0 / D) ** 0.5),
            "W_down": _w((lambda *s: torch.randn(*s, dtype=torch.bfloat16) * 0.4)(F, D) * (1.0 / F) ** 0.5),
        }
    _B_in = _B_setup()

    return {
        "A_x": _A_in["x"],
        "A_wqkv": _A_in["wqkv"],
        "A_wo": _A_in["wo"],
        "B_x": _B_in["x"],
        "B_W_gate": _B_in["W_gate"],
        "B_W_up": _B_in["W_up"],
        "B_W_down": _B_in["W_down"],
    }

def reference(A_x, A_wqkv, A_wo, B_x, B_W_gate, B_W_up, B_W_down):
    def _A_ref(x, wqkv, wo):
        B, S, D = x.shape
        H = 32; Dh = D // H
        qkv = (lambda x, *d: x.permute(*d))((x @ wqkv).reshape(B, S, 3, H, Dh), 2, 0, 3, 1, 4)
        q, k, v = qkv[0], qkv[1], qkv[2]
        scale = Dh ** -0.5
        scores = torch.einsum("bhqd,bhkd->bhqk", q, k) * scale
        p = _softmax(scores, axis=-1)
        o = torch.einsum("bhqk,bhkd->bhqd", p, v)
        return (lambda x, *d: x.permute(*d))(o, 0, 2, 1, 3).reshape(B, S, D) @ wo

    def _B_ref(x, W_gate, W_up, W_down):
        gate = torch.einsum("bsd,df->bsf", x, W_gate)
        up = torch.einsum("bsd,df->bsf", x, W_up)
        gate = gate * (lambda x, dt: x.to(dt))(gate > 0, gate.dtype)
        h = gate * up
        return torch.einsum("bsf,fd->bsd", h, W_down)

    x = A_x
    x = x + _A_ref(_layernorm(x, axis=-1), A_wqkv, A_wo)
    x = x + _B_ref(_layernorm(x, axis=-1), B_W_gate, B_W_up, B_W_down)
    x = x + _A_ref(_layernorm(x, axis=-1), A_wqkv, A_wo)
    x = x + _B_ref(_layernorm(x, axis=-1), B_W_gate, B_W_up, B_W_down)
    return x
```

```asm
; @launch kernel=prep_kernel grid=(608,1,1) block=(256,1,1) lds=16384
; @launch kernel=main_kernel grid=(256,1,1) block=(256,1,1) lds=163840
.amdgcn_target "amdgcn-amd-amdhsa--gfx950"
.text
.globl prep_kernel
.p2align 8
.type prep_kernel,@function
prep_kernel:
    s_cmp_ge_u32 s2, 608
    s_cbranch_scc1 LP_end
    s_load_dwordx2 s[4:5], s[0:1], 72
    s_load_dwordx4 s[68:71], s[0:1], 0
    s_load_dwordx2 s[72:73], s[0:1], 16
    s_load_dwordx4 s[76:79], s[0:1], 32
    s_load_dwordx2 s[74:75], s[0:1], 48
    v_lshrrev_b32 v1, 6, v0
    v_and_b32 v2, 63, v0
    v_readfirstlane_b32 s3, v1
    v_and_b32 v3, 15, v2
    v_lshrrev_b32 v4, 4, v2
    v_lshlrev_b32 v10, 4, v2
    s_waitcnt lgkmcnt(0)
    s_mov_b32 s8, s4
    s_mov_b32 s9, s5
    s_mov_b32 s10, 0x3600000
    s_mov_b32 s11, 0x00020000
    s_cmp_ge_u32 s2, 480
    s_cbranch_scc1 LP_d
    s_cmp_ge_u32 s2, 256
    s_cbranch_scc1 LP_g
    s_cmp_ge_u32 s2, 224
    s_cbranch_scc1 LP_o
    s_cmp_ge_u32 s2, 96
    s_cbranch_scc1 LP_x
    s_mov_b32 s12, s70
    s_mov_b32 s13, s71
    s_mov_b32 s14, 0x180000
    s_mov_b32 s15, 0x00020000
    s_lshr_b32 s46, s2, 2
    s_and_b32 s47, s2, 3
    s_mov_b32 s30, 3072
    s_mul_i32 s31, s47, 393216
    s_lshl_b32 s48, s46, 7
    s_add_u32 s31, s31, s48
    s_lshl_b32 s48, s46, 2
    s_add_u32 s48, s48, s3
    s_lshr_b32 s49, s48, 5
    s_and_b32 s50, s48, 31
    s_lshr_b32 s51, s50, 1
    s_and_b32 s50, s50, 1
    s_lshl_b32 s49, s49, 1
    s_add_u32 s49, s49, s50
    s_lshl_b32 s32, s51, 4
    s_lshl_b32 s50, s47, 2
    s_add_u32 s32, s32, s50
    s_mul_i32 s32, s32, 6
    s_add_u32 s32, s32, s49
    s_lshl_b32 s32, s32, 10
    s_add_u32 s32, s32, 0x0
    s_mov_b32 s33, 6144
    s_mov_b32 s34, 0
    s_mul_i32 s35, s51, 6
    s_add_u32 s35, s35, s49
    s_lshl_b32 s35, s35, 9
    s_lshl_b32 s50, s47, 7
    s_add_u32 s35, s35, s50
    s_add_u32 s35, s35, 0x900000
    s_branch LP_w
LP_o:
    s_mov_b32 s12, s72
    s_mov_b32 s13, s73
    s_mov_b32 s14, 0x80000
    s_mov_b32 s15, 0x00020000
    s_sub_u32 s46, s2, 224
    s_and_b32 s47, s46, 3
    s_lshr_b32 s46, s46, 2
    s_mov_b32 s30, 1024
    s_lshl_b32 s31, s47, 17
    s_lshl_b32 s48, s46, 7
    s_add_u32 s31, s31, s48
    s_lshl_b32 s32, s46, 4
    s_lshl_b32 s50, s47, 2
    s_add_u32 s32, s32, s50
    s_lshl_b32 s32, s32, 2
    s_add_u32 s32, s32, s3
    s_lshl_b32 s32, s32, 10
    s_add_u32 s32, s32, 0x200000
    s_mov_b32 s33, 4096
    s_mov_b32 s34, 1
    s_mov_b32 s35, 0
    s_branch LP_w
LP_d:
    s_mov_b32 s12, s74
    s_mov_b32 s13, s75
    s_mov_b32 s14, 0x1c0000
    s_mov_b32 s15, 0x00020000
    s_sub_u32 s46, s2, 480
    s_and_b32 s47, s46, 7
    s_lshr_b32 s46, s46, 3
    s_mov_b32 s30, 1024
    s_mul_i32 s31, s46, 114688
    s_lshl_b32 s48, s47, 7
    s_add_u32 s31, s31, s48
    s_lshl_b32 s32, s47, 4
    s_add_u32 s32, s32, s46
    s_mul_i32 s32, s32, 14336
    s_add_u32 s32, s32, 0x700000
    s_mov_b32 s33, 4096
    s_mov_b32 s34, 2
    s_mov_b32 s35, 0
    s_branch LP_w
LP_g:
    s_mov_b32 s12, s76
    s_mov_b32 s13, s77
    s_mov_b32 s14, 0x1c0000
    s_mov_b32 s15, 0x00020000
    s_sub_u32 s46, s2, 256
    s_mov_b32 s52, 0
    s_cmp_lt_u32 s46, 112
    s_cbranch_scc1 LP_g2
    s_sub_u32 s46, s46, 112
    s_mov_b32 s52, 1
    s_mov_b32 s12, s78
    s_mov_b32 s13, s79
LP_g2:
    s_and_b32 s47, s46, 3
    s_lshr_b32 s46, s46, 2
    s_mov_b32 s30, 3584
    s_mul_i32 s31, s47, 458752
    s_lshl_b32 s48, s46, 7
    s_add_u32 s31, s31, s48
    s_lshl_b32 s48, s46, 2
    s_add_u32 s48, s48, s3
    s_mul_i32 s51, s48, 147
    s_lshr_b32 s51, s51, 10
    s_mul_i32 s49, s51, 7
    s_sub_u32 s49, s48, s49
    s_lshl_b32 s49, s49, 1
    s_add_u32 s49, s49, s52
    s_mul_i32 s32, s51, 224
    s_add_u32 s32, s32, s49
    s_mov_b32 s33, 8192
    s_cmp_lt_u32 s49, 8
    s_cbranch_scc1 LP_g3
    s_add_u32 s32, s32, 120
    s_mov_b32 s33, 6144
LP_g3:
    s_lshl_b32 s32, s32, 10
    s_lshl_b32 s50, s33, 2
    s_mul_i32 s50, s50, s47
    s_add_u32 s32, s32, s50
    s_add_u32 s32, s32, 0x300000
    s_mov_b32 s34, 0
    s_mul_i32 s35, s51, 14
    s_add_u32 s35, s35, s49
    s_lshl_b32 s35, s35, 9
    s_lshl_b32 s50, s47, 7
    s_add_u32 s35, s35, s50
    s_add_u32 s35, s35, 0x910000
LP_w:
    v_lshrrev_b32 v17, 3, v2
    v_mul_lo_u32 v17, v17, s30
    v_and_b32 v18, 7, v2
    v_lshl_add_u32 v17, v18, 4, v17
    s_lshl_b32 s46, s30, 3
    s_lshl_b32 s47, s3, 2
    s_mul_i32 s47, s47, s46
    s_add_u32 s47, s47, s31
    s_lshl_b32 s48, s3, 12
    s_mov_b32 m0, s48
    s_add_u32 s48, s48, 1024
    buffer_load_dwordx4 v17, s[12:15], s47 offen lds
    s_add_u32 s47, s47, s46
    s_mov_b32 m0, s48
    s_add_u32 s48, s48, 1024
    buffer_load_dwordx4 v17, s[12:15], s47 offen lds
    s_add_u32 s47, s47, s46
    s_mov_b32 m0, s48
    s_add_u32 s48, s48, 1024
    buffer_load_dwordx4 v17, s[12:15], s47 offen lds
    s_add_u32 s47, s47, s46
    s_mov_b32 m0, s48
    s_add_u32 s48, s48, 1024
    buffer_load_dwordx4 v17, s[12:15], s47 offen lds
    s_add_u32 s47, s47, s46
    v_lshrrev_b32 v18, 2, v3
    v_and_b32 v19, 3, v3
    v_lshlrev_b32 v19, 3, v19
    s_lshl_b32 s46, s3, 5
    v_add_u32 v19, s46, v19
    v_lshl_add_u32 v20, v4, 2, v18
    v_lshrrev_b32 v21, 1, v4
    v_lshlrev_b32 v21, 4, v21
    v_and_b32 v22, 1, v4
    v_lshl_add_u32 v21, v22, 2, v21
    v_add_u32 v21, v21, v18
    v_lshl_add_u32 v20, v20, 7, v19
    v_lshl_add_u32 v21, v21, 7, v19
    v_lshlrev_b32 v23, 3, v3
    v_mov_b32 v24, 0x3f803f80
    v_mov_b32 v25, 0x3f803f80
    v_mov_b32 v26, 0x3f803f80
    v_mov_b32 v27, 0x3f803f80
    s_waitcnt vmcnt(0)
    s_barrier
    s_cmp_eq_u32 s34, 1
    s_cbranch_scc1 LP_pi2
    s_cmp_eq_u32 s34, 2
    s_cbranch_scc1 LP_dn
    ds_read_b64_tr_b16 v[32:33], v20 offset:0
    ds_read_b64_tr_b16 v[34:35], v20 offset:2048
    ds_read_b64_tr_b16 v[36:37], v20 offset:4096
    ds_read_b64_tr_b16 v[38:39], v20 offset:6144
    ds_read_b64_tr_b16 v[40:41], v20 offset:8192
    ds_read_b64_tr_b16 v[42:43], v20 offset:10240
    ds_read_b64_tr_b16 v[44:45], v20 offset:12288
    ds_read_b64_tr_b16 v[46:47], v20 offset:14336
    s_mov_b32 s46, s32
    s_waitcnt lgkmcnt(6)
    buffer_store_dwordx4 v[32:35], v10, s[8:11], s46 offen
    v_mfma_f32_16x16x32_bf16 v[28:31], v[24:27], v[32:35], 0
    s_add_u32 s46, s46, s33
    s_waitcnt lgkmcnt(4)
    buffer_store_dwordx4 v[36:39], v10, s[8:11], s46 offen
    v_mfma_f32_16x16x32_bf16 v[28:31], v[24:27], v[36:39], v[28:31]
    s_add_u32 s46, s46, s33
    s_waitcnt lgkmcnt(2)
    buffer_store_dwordx4 v[40:43], v10, s[8:11], s46 offen
    v_mfma_f32_16x16x32_bf16 v[28:31], v[24:27], v[40:43], v[28:31]
    s_add_u32 s46, s46, s33
    s_waitcnt lgkmcnt(0)
    buffer_store_dwordx4 v[44:47], v10, s[8:11], s46 offen
    v_mfma_f32_16x16x32_bf16 v[28:31], v[24:27], v[44:47], v[28:31]
    s_add_u32 s46, s46, s33
    s_nop 7
    v_and_b32 v50, 0xffff0000, v28
    v_sub_f32 v28, v28, v50
    v_lshrrev_b32 v48, 16, v50
    v_or_b32 v48, v48, v50
    v_cvt_pk_bf16_f32 v49, v28, 0
    s_mov_b64 exec, 0xffff
    buffer_store_dwordx2 v[48:49], v23, s[8:11], s35 offen
    s_branch LP_end
LP_pi2:
    ds_read_b64_tr_b16 v[32:33], v21 offset:0
    ds_read_b64_tr_b16 v[34:35], v21 offset:1024
    ds_read_b64_tr_b16 v[36:37], v21 offset:4096
    ds_read_b64_tr_b16 v[38:39], v21 offset:5120
    ds_read_b64_tr_b16 v[40:41], v21 offset:8192
    ds_read_b64_tr_b16 v[42:43], v21 offset:9216
    ds_read_b64_tr_b16 v[44:45], v21 offset:12288
    ds_read_b64_tr_b16 v[46:47], v21 offset:13312
    s_mov_b32 s46, s32
    s_waitcnt lgkmcnt(6)
    buffer_store_dwordx4 v[32:35], v10, s[8:11], s46 offen
    s_add_u32 s46, s46, s33
    s_waitcnt lgkmcnt(4)
    buffer_store_dwordx4 v[36:39], v10, s[8:11], s46 offen
    s_add_u32 s46, s46, s33
    s_waitcnt lgkmcnt(2)
    buffer_store_dwordx4 v[40:43], v10, s[8:11], s46 offen
    s_add_u32 s46, s46, s33
    s_waitcnt lgkmcnt(0)
    buffer_store_dwordx4 v[44:47], v10, s[8:11], s46 offen
    s_add_u32 s46, s46, s33
    s_branch LP_end
LP_dn:
    ds_read_b64_tr_b16 v[32:33], v20 offset:0
    ds_read_b64_tr_b16 v[34:35], v20 offset:2048
    ds_read_b64_tr_b16 v[36:37], v20 offset:4096
    ds_read_b64_tr_b16 v[38:39], v20 offset:6144
    ds_read_b64_tr_b16 v[40:41], v20 offset:8192
    ds_read_b64_tr_b16 v[42:43], v20 offset:10240
    ds_read_b64_tr_b16 v[44:45], v20 offset:12288
    s_lshl_b32 s46, s3, 10
    s_add_u32 s46, s46, s32
    s_lshr_b32 s47, s3, 1
    s_lshl_b32 s47, s47, 10
    s_and_b32 s48, s3, 1
    s_lshl_b32 s48, s48, 3
    s_add_u32 s47, s47, s48
    s_add_u32 s47, s47, s32
    s_add_u32 s47, s47, 12288
    s_waitcnt lgkmcnt(0)
    buffer_store_dwordx4 v[32:35], v10, s[8:11], s46 offen
    s_add_u32 s46, s46, 4096
    buffer_store_dwordx4 v[36:39], v10, s[8:11], s46 offen
    s_add_u32 s46, s46, 4096
    buffer_store_dwordx4 v[40:43], v10, s[8:11], s46 offen
    s_add_u32 s46, s46, 4096
    buffer_store_dwordx2 v[44:45], v10, s[8:11], s47 offen
    s_branch LP_end
LP_x:
    s_mov_b32 s12, s68
    s_mov_b32 s13, s69
    s_mov_b32 s14, 0x200000
    s_mov_b32 s15, 0x00020000
    s_sub_u32 s23, s2, 96
    s_lshl_b32 s24, s23, 14
    s_lshl_b32 s25, s3, 8
    s_add_u32 s24, s24, s25
    v_lshlrev_b32 v5, 10, v3
    v_lshl_add_u32 v5, v4, 3, v5
    buffer_load_dwordx2 v[32:33], v5, s[12:15], s24 offen offset:0
    buffer_load_dwordx2 v[34:35], v5, s[12:15], s24 offen offset:32
    buffer_load_dwordx2 v[36:37], v5, s[12:15], s24 offen offset:64
    buffer_load_dwordx2 v[38:39], v5, s[12:15], s24 offen offset:96
    buffer_load_dwordx2 v[40:41], v5, s[12:15], s24 offen offset:128
    buffer_load_dwordx2 v[42:43], v5, s[12:15], s24 offen offset:160
    buffer_load_dwordx2 v[44:45], v5, s[12:15], s24 offen offset:192
    buffer_load_dwordx2 v[46:47], v5, s[12:15], s24 offen offset:224
    s_lshr_b32 s26, s23, 1
    s_lshl_b32 s26, s26, 4
    s_lshl_b32 s27, s3, 2
    s_add_u32 s26, s26, s27
    s_lshl_b32 s26, s26, 1
    s_and_b32 s27, s23, 1
    s_add_u32 s26, s26, s27
    s_lshl_b32 s26, s26, 10
    s_add_u32 s26, s26, 0xa00000
    s_add_u32 s27, s26, 4096
    v_mov_b32 v12, 0x3f803f80
    v_mov_b32 v16, 0
    v_mov_b32 v17, 0
    v_mov_b32 v18, 0
    v_mov_b32 v19, 0
    s_cmp_ge_u32 s23, 10
    s_cbranch_scc1 LP_nz
    s_lshl_b32 s28, s23, 2
    s_add_u32 s28, s28, s3
    s_lshl_b32 s28, s28, 10
    s_add_u32 s28, s28, 0x930000
    buffer_store_dwordx4 v[16:19], v10, s[8:11], s28 offen
LP_nz:
    s_waitcnt vmcnt(0)
    buffer_store_dwordx4 v[32:35], v10, s[8:11], s26 offen
    buffer_store_dwordx4 v[36:39], v10, s[8:11], s26 offen offset:2048
    buffer_store_dwordx4 v[40:43], v10, s[8:11], s27 offen
    buffer_store_dwordx4 v[44:47], v10, s[8:11], s27 offen offset:2048
    v_dot2_f32_bf16 v16, v32, v12, v16
    v_dot2_f32_bf16 v17, v32, v32, v17
    v_dot2_f32_bf16 v16, v33, v12, v16
    v_dot2_f32_bf16 v17, v33, v33, v17
    v_dot2_f32_bf16 v16, v34, v12, v16
    v_dot2_f32_bf16 v17, v34, v34, v17
    v_dot2_f32_bf16 v16, v35, v12, v16
    v_dot2_f32_bf16 v17, v35, v35, v17
    v_dot2_f32_bf16 v16, v36, v12, v16
    v_dot2_f32_bf16 v17, v36, v36, v17
    v_dot2_f32_bf16 v16, v37, v12, v16
    v_dot2_f32_bf16 v17, v37, v37, v17
    v_dot2_f32_bf16 v16, v38, v12, v16
    v_dot2_f32_bf16 v17, v38, v38, v17
    v_dot2_f32_bf16 v16, v39, v12, v16
    v_dot2_f32_bf16 v17, v39, v39, v17
    v_dot2_f32_bf16 v18, v40, v12, v18
    v_dot2_f32_bf16 v19, v40, v40, v19
    v_dot2_f32_bf16 v18, v41, v12, v18
    v_dot2_f32_bf16 v19, v41, v41, v19
    v_dot2_f32_bf16 v18, v42, v12, v18
    v_dot2_f32_bf16 v19, v42, v42, v19
    v_dot2_f32_bf16 v18, v43, v12, v18
    v_dot2_f32_bf16 v19, v43, v43, v19
    v_dot2_f32_bf16 v18, v44, v12, v18
    v_dot2_f32_bf16 v19, v44, v44, v19
    v_dot2_f32_bf16 v18, v45, v12, v18
    v_dot2_f32_bf16 v19, v45, v45, v19
    v_dot2_f32_bf16 v18, v46, v12, v18
    v_dot2_f32_bf16 v19, v46, v46, v19
    v_dot2_f32_bf16 v18, v47, v12, v18
    v_dot2_f32_bf16 v19, v47, v47, v19
    s_nop 3
    v_mov_b32 v20, v16
    v_mov_b32 v21, v17
    v_mov_b32 v22, v18
    v_mov_b32 v23, v19
    s_nop 1
    v_permlane32_swap_b32 v16, v20
    v_permlane32_swap_b32 v17, v21
    v_permlane32_swap_b32 v18, v22
    v_permlane32_swap_b32 v19, v23
    s_nop 1
    v_add_f32 v16, v16, v20
    v_add_f32 v17, v17, v21
    v_add_f32 v18, v18, v22
    v_add_f32 v19, v19, v23
    v_mov_b32 v20, v16
    v_mov_b32 v21, v17
    v_mov_b32 v22, v18
    v_mov_b32 v23, v19
    s_nop 1
    v_permlane16_swap_b32 v16, v20
    v_permlane16_swap_b32 v17, v21
    v_permlane16_swap_b32 v18, v22
    v_permlane16_swap_b32 v19, v23
    s_nop 1
    v_add_f32 v16, v16, v20
    v_add_f32 v17, v17, v21
    v_add_f32 v18, v18, v22
    v_add_f32 v19, v19, v23
    s_lshl_b32 s26, s23, 10
    s_lshl_b32 s27, s3, 8
    s_add_u32 s26, s26, s27
    s_add_u32 s26, s26, 0x1d80000
    v_lshlrev_b32 v11, 3, v3
    v_cmp_eq_u32 vcc, 0, v4
    s_and_saveexec_b64 s[30:31], vcc
    buffer_store_dwordx2 v[16:17], v11, s[8:11], s26 offen
    buffer_store_dwordx2 v[18:19], v11, s[8:11], s26 offen offset:128
LP_end:
    s_endpgm
.globl main_kernel
.p2align 8
.type main_kernel,@function
main_kernel:
    s_cmp_ge_u32 s2, 256
    s_cbranch_scc1 LM_end
    s_load_dwordx2 s[4:5], s[0:1], 72
    s_load_dwordx2 s[6:7], s[0:1], 56
    v_lshrrev_b32 v1, 6, v0
    v_and_b32 v2, 63, v0
    v_readfirstlane_b32 s3, v1
    v_and_b32 v3, 15, v2
    v_lshrrev_b32 v4, 4, v2
    v_lshlrev_b32 v1, 4, v2
    v_lshlrev_b32 v5, 2, v2
    v_cmp_gt_u32 vcc, 16, v2
    v_add_u32 v14, 0x10000, v1
    v_add_u32 v15, 0x20000, v1
    v_cndmask_b32 v9, 0, -1, vcc
    s_and_b32 s30, s2, 7
    s_lshr_b32 s31, s2, 3
    s_and_b32 s32, s31, 3
    s_lshr_b32 s33, s31, 2
    s_lshr_b32 s16, s30, 1
    s_lshl_b32 s16, s16, 2
    s_add_u32 s16, s16, s32
    s_and_b32 s17, s30, 1
    s_lshl_b32 s17, s17, 3
    s_add_u32 s17, s17, s33
    s_lshl_b32 s18, s30, 2
    s_add_u32 s18, s18, s32
    s_mov_b32 s19, s33
    s_mov_b32 s20, s18
    s_mov_b32 s21, s33
    s_lshr_b32 s22, s30, 2
    s_lshl_b32 s22, s22, 3
    s_and_b32 s34, s31, 7
    s_add_u32 s22, s22, s34
    s_and_b32 s23, s30, 3
    s_lshl_b32 s23, s23, 2
    s_lshr_b32 s34, s31, 3
    s_add_u32 s23, s23, s34
    s_mov_b32 s24, 0
    s_mov_b32 s25, 0
    s_mov_b32 s26, 0x930000
    s_xor_b32 s34, s3, 0
    s_lshl_b32 s34, s34, 10
    v_add_u32 v10, s34, v1
    s_xor_b32 s34, s3, 1
    s_lshl_b32 s34, s34, 10
    v_add_u32 v11, s34, v1
    s_xor_b32 s34, s3, 2
    s_lshl_b32 s34, s34, 10
    v_add_u32 v12, s34, v1
    s_xor_b32 s34, s3, 3
    s_lshl_b32 s34, s34, 10
    v_add_u32 v13, s34, v1
    v_lshlrev_b32 v8, 8, v4
    v_lshl_add_u32 v8, v3, 3, v8
    s_waitcnt lgkmcnt(0)
    s_mov_b32 s8, s4
    s_mov_b32 s9, s5
    s_mov_b32 s10, 0x3600000
    s_mov_b32 s11, 0x00020000
    s_mov_b32 s12, s6
    s_mov_b32 s13, s7
    s_mov_b32 s14, 0x200000
    s_mov_b32 s15, 0x00020000
    v_lshlrev_b32 v7, 3, v2
    s_mul_i32 s32, s17, 3072
    s_add_u32 s32, s32, 0x900000
    buffer_load_dwordx2 v[112:113], v7, s[8:11], s32 offen offset:0
    buffer_load_dwordx2 v[114:115], v7, s[8:11], s32 offen offset:512
    buffer_load_dwordx2 v[116:117], v7, s[8:11], s32 offen offset:1024
    buffer_load_dwordx2 v[118:119], v7, s[8:11], s32 offen offset:1536
    buffer_load_dwordx2 v[120:121], v7, s[8:11], s32 offen offset:2048
    buffer_load_dwordx2 v[122:123], v7, s[8:11], s32 offen offset:2560
    s_mul_i32 s30, s17, 98304
    s_add_u32 s30, s30, 0x0
    s_mul_i32 s31, s3, 3072
    s_add_u32 s30, s30, s31
    s_mov_b32 m0, s31
    s_add_u32 s31, s31, 12288
    buffer_load_dwordx4 v1, s[8:11], s30 offen offset:0 lds
    buffer_load_dwordx4 v1, s[8:11], s30 offen offset:1024 lds
    buffer_load_dwordx4 v1, s[8:11], s30 offen offset:2048 lds
    s_add_u32 s30, s30, 12288
    s_mov_b32 m0, s31
    s_add_u32 s31, s31, 12288
    buffer_load_dwordx4 v1, s[8:11], s30 offen offset:0 lds
    buffer_load_dwordx4 v1, s[8:11], s30 offen offset:1024 lds
    buffer_load_dwordx4 v1, s[8:11], s30 offen offset:2048 lds
    s_add_u32 s30, s30, 12288
    s_mov_b32 m0, s31
    s_add_u32 s31, s31, 12288
    buffer_load_dwordx4 v1, s[8:11], s30 offen offset:0 lds
    buffer_load_dwordx4 v1, s[8:11], s30 offen offset:1024 lds
    buffer_load_dwordx4 v1, s[8:11], s30 offen offset:2048 lds
    s_add_u32 s30, s30, 12288
    s_mov_b32 m0, s31
    s_add_u32 s31, s31, 12288
    buffer_load_dwordx4 v1, s[8:11], s30 offen offset:0 lds
    buffer_load_dwordx4 v1, s[8:11], s30 offen offset:1024 lds
    buffer_load_dwordx4 v1, s[8:11], s30 offen offset:2048 lds
    s_add_u32 s30, s30, 12288
    s_mov_b32 m0, s31
    s_add_u32 s31, s31, 12288
    buffer_load_dwordx4 v1, s[8:11], s30 offen offset:0 lds
    buffer_load_dwordx4 v1, s[8:11], s30 offen offset:1024 lds
    buffer_load_dwordx4 v1, s[8:11], s30 offen offset:2048 lds
    s_add_u32 s30, s30, 12288
    s_mov_b32 m0, s31
    s_add_u32 s31, s31, 12288
    buffer_load_dwordx4 v1, s[8:11], s30 offen offset:0 lds
    buffer_load_dwordx4 v1, s[8:11], s30 offen offset:1024 lds
    buffer_load_dwordx4 v1, s[8:11], s30 offen offset:2048 lds
    s_add_u32 s30, s30, 12288
    s_mov_b32 m0, s31
    s_add_u32 s31, s31, 12288
    buffer_load_dwordx4 v1, s[8:11], s30 offen offset:0 lds
    buffer_load_dwordx4 v1, s[8:11], s30 offen offset:1024 lds
    buffer_load_dwordx4 v1, s[8:11], s30 offen offset:2048 lds
    s_add_u32 s30, s30, 12288
    s_mov_b32 m0, s31
    s_add_u32 s31, s31, 12288
    buffer_load_dwordx4 v1, s[8:11], s30 offen offset:0 lds
    buffer_load_dwordx4 v1, s[8:11], s30 offen offset:1024 lds
    buffer_load_dwordx4 v1, s[8:11], s30 offen offset:2048 lds
    s_add_u32 s30, s30, 12288
    s_lshl_b32 s44, s20, 2
    s_add_u32 s44, s44, s3
    s_and_b32 s45, s44, 1
    s_lshr_b32 s44, s44, 1
    s_lshl_b32 s44, s44, 4
    s_lshl_b32 s46, s21, 1
    s_add_u32 s44, s44, s46
    s_lshl_b32 s44, s44, 1
    s_add_u32 s44, s44, s45
    s_lshl_b32 s44, s44, 10
    s_add_u32 s44, s44, 0xa00000
    s_add_u32 s44, s44, s24
    buffer_load_dwordx4 v[248:251], v1, s[8:11], s44 offen
    buffer_load_dwordx4 v[252:255], v1, s[8:11], s44 offen offset:2048
    s_branch LM_q0
LM_layer:
    v_lshlrev_b32 v7, 3, v2
    s_mul_i32 s32, s17, 3072
    s_add_u32 s32, s32, 0x900000
    buffer_load_dwordx2 v[112:113], v7, s[8:11], s32 offen offset:0
    buffer_load_dwordx2 v[114:115], v7, s[8:11], s32 offen offset:512
    buffer_load_dwordx2 v[116:117], v7, s[8:11], s32 offen offset:1024
    buffer_load_dwordx2 v[118:119], v7, s[8:11], s32 offen offset:1536
    buffer_load_dwordx2 v[120:121], v7, s[8:11], s32 offen offset:2048
    buffer_load_dwordx2 v[122:123], v7, s[8:11], s32 offen offset:2560
    s_cmp_lg_u32 s3, 0
    s_cbranch_scc1 LPO_0
    s_lshl_b32 s40, s16, 8
    s_add_u32 s40, s40, s26
    s_sub_u32 s40, s40, 4096
    s_mov_b32 s42, 0xffff
    s_mov_b32 s43, 0
    s_mov_b64 exec, s[42:43]
    s_mov_b32 s41, 0
LPL_0:
    buffer_load_dword v6, v5, s[8:11], s40 offen sc1
    s_add_u32 s41, s41, 1
    s_waitcnt vmcnt(0)
    v_cmp_ne_u32 vcc, 1, v6
    s_cmp_gt_u32 s41, 100000
    s_cbranch_scc1 LPX_0
    s_nop 2
    s_cbranch_vccnz LPL_0
LPX_0:
    s_mov_b64 exec, -1
LPO_0:
    s_barrier
LM_q0:
    s_lshl_b32 s30, s16, 2
    s_add_u32 s30, s30, s3
    s_lshl_b32 s33, s30, 15
    s_add_u32 s33, s33, 0xa00000
    s_add_u32 s33, s33, s24
    buffer_load_dwordx4 a[0:3], v1, s[8:11], s33 offen offset:0 sc1
    buffer_load_dwordx4 a[4:7], v1, s[8:11], s33 offen offset:1024 sc1
    buffer_load_dwordx4 a[8:11], v1, s[8:11], s33 offen offset:2048 sc1
    buffer_load_dwordx4 a[12:15], v1, s[8:11], s33 offen offset:3072 sc1
    s_add_u32 s33, s33, 4096
    s_lshl_b32 s31, s30, 11
    s_add_u32 s31, s31, 0x1d80000
    s_add_u32 s31, s31, s24
    buffer_load_dwordx2 v[132:133], v8, s[8:11], s31 offen offset:0 sc1
    buffer_load_dwordx2 v[134:135], v8, s[8:11], s31 offen offset:128 sc1
    buffer_load_dwordx2 v[136:137], v8, s[8:11], s31 offen offset:1024 sc1
    buffer_load_dwordx2 v[138:139], v8, s[8:11], s31 offen offset:1152 sc1
    buffer_load_dwordx4 a[16:19], v1, s[8:11], s33 offen offset:0 sc1
    buffer_load_dwordx4 a[20:23], v1, s[8:11], s33 offen offset:1024 sc1
    buffer_load_dwordx4 a[24:27], v1, s[8:11], s33 offen offset:2048 sc1
    buffer_load_dwordx4 a[28:31], v1, s[8:11], s33 offen offset:3072 sc1
    s_add_u32 s33, s33, 4096
    buffer_load_dwordx4 a[32:35], v1, s[8:11], s33 offen offset:0 sc1
    buffer_load_dwordx4 a[36:39], v1, s[8:11], s33 offen offset:1024 sc1
    buffer_load_dwordx4 a[40:43], v1, s[8:11], s33 offen offset:2048 sc1
    buffer_load_dwordx4 a[44:47], v1, s[8:11], s33 offen offset:3072 sc1
    s_add_u32 s33, s33, 4096
    buffer_load_dwordx4 a[48:51], v1, s[8:11], s33 offen offset:0 sc1
    buffer_load_dwordx4 a[52:55], v1, s[8:11], s33 offen offset:1024 sc1
    buffer_load_dwordx4 a[56:59], v1, s[8:11], s33 offen offset:2048 sc1
    buffer_load_dwordx4 a[60:63], v1, s[8:11], s33 offen offset:3072 sc1
    s_add_u32 s33, s33, 4096
    s_waitcnt vmcnt(18)
    s_barrier
    ds_read_b128 v[64:67], v1 offset:0
    ds_read_b128 v[68:71], v1 offset:1024
    ds_read_b128 v[72:75], v1 offset:2048
    ds_read_b128 v[76:79], v1 offset:3072
    ds_read_b128 v[80:83], v1 offset:4096
    ds_read_b128 v[84:87], v1 offset:5120
    ds_read_b128 v[88:91], v1 offset:6144
    s_waitcnt lgkmcnt(6)
    v_mfma_f32_16x16x32_bf16 v[16:19], v[64:67], a[0:3], 0
    v_mfma_f32_16x16x32_bf16 v[20:23], v[64:67], a[4:7], 0
    ds_read_b128 v[92:95], v1 offset:7168
    s_waitcnt lgkmcnt(6)
    v_mfma_f32_16x16x32_bf16 v[24:27], v[68:71], a[0:3], 0
    v_mfma_f32_16x16x32_bf16 v[28:31], v[68:71], a[4:7], 0
    ds_read_b128 v[96:99], v1 offset:8192
    s_waitcnt lgkmcnt(6)
    v_mfma_f32_16x16x32_bf16 v[32:35], v[72:75], a[0:3], 0
    v_mfma_f32_16x16x32_bf16 v[36:39], v[72:75], a[4:7], 0
    buffer_load_dwordx4 a[64:67], v1, s[8:11], s33 offen offset:0 sc1
    buffer_load_dwordx4 a[68:71], v1, s[8:11], s33 offen offset:1024 sc1
    ds_read_b128 v[100:103], v1 offset:9216
    s_waitcnt lgkmcnt(6)
    v_mfma_f32_16x16x32_bf16 v[40:43], v[76:79], a[0:3], 0
    v_mfma_f32_16x16x32_bf16 v[44:47], v[76:79], a[4:7], 0
    ds_read_b128 v[104:107], v1 offset:10240
    s_waitcnt lgkmcnt(6)
    v_mfma_f32_16x16x32_bf16 v[48:51], a[0:3], v[80:83], 0
    v_mfma_f32_16x16x32_bf16 v[52:55], a[4:7], v[80:83], 0
    ds_read_b128 v[108:111], v1 offset:11264
    s_waitcnt lgkmcnt(6)
    v_mfma_f32_16x16x32_bf16 v[56:59], a[0:3], v[84:87], 0
    v_mfma_f32_16x16x32_bf16 v[60:63], a[4:7], v[84:87], 0
    s_waitcnt vmcnt(18)
    ds_read_b128 v[64:67], v1 offset:12288
    s_waitcnt lgkmcnt(6)
    v_mfma_f32_16x16x32_bf16 v[16:19], v[88:91], a[8:11], v[16:19]
    v_mfma_f32_16x16x32_bf16 v[20:23], v[88:91], a[12:15], v[20:23]
    ds_read_b128 v[68:71], v1 offset:13312
    s_waitcnt lgkmcnt(6)
    v_mfma_f32_16x16x32_bf16 v[24:27], v[92:95], a[8:11], v[24:27]
    v_mfma_f32_16x16x32_bf16 v[28:31], v[92:95], a[12:15], v[28:31]
    ds_read_b128 v[72:75], v1 offset:14336
    s_waitcnt lgkmcnt(6)
    v_mfma_f32_16x16x32_bf16 v[32:35], v[96:99], a[8:11], v[32:35]
    v_mfma_f32_16x16x32_bf16 v[36:39], v[96:99], a[12:15], v[36:39]
    buffer_load_dwordx4 a[72:75], v1, s[8:11], s33 offen offset:2048 sc1
    buffer_load_dwordx4 a[76:79], v1, s[8:11], s33 offen offset:3072 sc1
    s_add_u32 s33, s33, 4096
    ds_read_b128 v[76:79], v1 offset:15360
    s_waitcnt lgkmcnt(6)
    v_mfma_f32_16x16x32_bf16 v[40:43], v[100:103], a[8:11], v[40:43]
    v_mfma_f32_16x16x32_bf16 v[44:47], v[100:103], a[12:15], v[44:47]
    ds_read_b128 v[80:83], v1 offset:16384
    s_waitcnt lgkmcnt(6)
    v_mfma_f32_16x16x32_bf16 v[48:51], a[8:11], v[104:107], v[48:51]
    v_mfma_f32_16x16x32_bf16 v[52:55], a[12:15], v[104:107], v[52:55]
    ds_read_b128 v[84:87], v1 offset:17408
    s_waitcnt lgkmcnt(6)
    v_mfma_f32_16x16x32_bf16 v[56:59], a[8:11], v[108:111], v[56:59]
    v_mfma_f32_16x16x32_bf16 v[60:63], a[12:15], v[108:111], v[60:63]
    s_waitcnt vmcnt(14)
    ds_read_b128 v[88:91], v1 offset:18432
    s_waitcnt lgkmcnt(6)
    v_mfma_f32_16x16x32_bf16 v[16:19], v[64:67], a[16:19], v[16:19]
    v_mfma_f32_16x16x32_bf16 v[20:23], v[64:67], a[20:23], v[20:23]
    ds_read_b128 v[92:95], v1 offset:19456
    s_waitcnt lgkmcnt(6)
    v_mfma_f32_16x16x32_bf16 v[24:27], v[68:71], a[16:19], v[24:27]
    v_mfma_f32_16x16x32_bf16 v[28:31], v[68:71], a[20:23], v[28:31]
    ds_read_b128 v[96:99], v1 offset:20480
    s_waitcnt lgkmcnt(6)
    v_mfma_f32_16x16x32_bf16 v[32:35], v[72:75], a[16:19], v[32:35]
    v_mfma_f32_16x16x32_bf16 v[36:39], v[72:75], a[20:23], v[36:39]
    buffer_load_dwordx4 a[80:83], v1, s[8:11], s33 offen offset:0 sc1
    buffer_load_dwordx4 a[84:87], v1, s[8:11], s33 offen offset:1024 sc1
    ds_read_b128 v[100:103], v1 offset:21504
    s_waitcnt lgkmcnt(6)
    v_mfma_f32_16x16x32_bf16 v[40:43], v[76:79], a[16:19], v[40:43]
    v_mfma_f32_16x16x32_bf16 v[44:47], v[76:79], a[20:23], v[44:47]
    ds_read_b128 v[104:107], v1 offset:22528
    s_waitcnt lgkmcnt(6)
    v_mfma_f32_16x16x32_bf16 v[48:51], a[16:19], v[80:83], v[48:51]
    v_mfma_f32_16x16x32_bf16 v[52:55], a[20:23], v[80:83], v[52:55]
    ds_read_b128 v[108:111], v1 offset:23552
    s_waitcnt lgkmcnt(6)
    v_mfma_f32_16x16x32_bf16 v[56:59], a[16:19], v[84:87], v[56:59]
    v_mfma_f32_16x16x32_bf16 v[60:63], a[20:23], v[84:87], v[60:63]
    s_waitcnt vmcnt(14)
    ds_read_b128 v[64:67], v1 offset:24576
    s_waitcnt lgkmcnt(6)
    v_mfma_f32_16x16x32_bf16 v[16:19], v[88:91], a[24:27], v[16:19]
    v_mfma_f32_16x16x32_bf16 v[20:23], v[88:91], a[28:31], v[20:23]
    ds_read_b128 v[68:71], v1 offset:25600
    s_waitcnt lgkmcnt(6)
    v_mfma_f32_16x16x32_bf16 v[24:27], v[92:95], a[24:27], v[24:27]
    v_mfma_f32_16x16x32_bf16 v[28:31], v[92:95], a[28:31], v[28:31]
    ds_read_b128 v[72:75], v1 offset:26624
    s_waitcnt lgkmcnt(6)
    v_mfma_f32_16x16x32_bf16 v[32:35], v[96:99], a[24:27], v[32:35]
    v_mfma_f32_16x16x32_bf16 v[36:39], v[96:99], a[28:31], v[36:39]
    buffer_load_dwordx4 a[88:91], v1, s[8:11], s33 offen offset:2048 sc1
    buffer_load_dwordx4 a[92:95], v1, s[8:11], s33 offen offset:3072 sc1
    s_add_u32 s33, s33, 4096
    ds_read_b128 v[76:79], v1 offset:27648
    s_waitcnt lgkmcnt(6)
    v_mfma_f32_16x16x32_bf16 v[40:43], v[100:103], a[24:27], v[40:43]
    v_mfma_f32_16x16x32_bf16 v[44:47], v[100:103], a[28:31], v[44:47]
    ds_read_b128 v[80:83], v1 offset:28672
    s_waitcnt lgkmcnt(6)
    v_mfma_f32_16x16x32_bf16 v[48:51], a[24:27], v[104:107], v[48:51]
    v_mfma_f32_16x16x32_bf16 v[52:55], a[28:31], v[104:107], v[52:55]
    ds_read_b128 v[84:87], v1 offset:29696
    s_waitcnt lgkmcnt(6)
    v_mfma_f32_16x16x32_bf16 v[56:59], a[24:27], v[108:111], v[56:59]
    v_mfma_f32_16x16x32_bf16 v[60:63], a[28:31], v[108:111], v[60:63]
    v_add_f32 v132, v132, v134
    v_add_f32 v133, v133, v135
    v_add_f32 v136, v136, v138
    v_add_f32 v137, v137, v139
    v_mov_b32 v156, v132
    v_mov_b32 v157, v133
    v_mov_b32 v158, v136
    v_mov_b32 v159, v137
    s_nop 1
    v_permlane32_swap_b32 v132, v156
    v_permlane32_swap_b32 v133, v157
    v_permlane32_swap_b32 v136, v158
    v_permlane32_swap_b32 v137, v159
    s_nop 1
    v_add_f32 v132, v132, v156
    v_add_f32 v133, v133, v157
    v_add_f32 v136, v136, v158
    v_add_f32 v137, v137, v159
    v_mov_b32 v156, v132
    v_mov_b32 v157, v133
    v_mov_b32 v158, v136
    v_mov_b32 v159, v137
    s_nop 1
    v_permlane16_swap_b32 v132, v156
    v_permlane16_swap_b32 v133, v157
    v_permlane16_swap_b32 v136, v158
    v_permlane16_swap_b32 v137, v159
    s_nop 1
    v_add_f32 v132, v132, v156
    v_add_f32 v133, v133, v157
    v_add_f32 v136, v136, v158
    v_add_f32 v137, v137, v159
    v_mul_f32 v140, 0xbb000000, v132
    v_mul_f32 v134, v140, v140
    v_mov_b32 v135, 0x3b000000
    v_fma_f32 v134, v133, v135, -v134
    v_max_f32 v134, 0, v134
    v_add_f32 v134, 0x3727c5ac, v134
    v_rsq_f32 v142, v134
    v_mul_f32 v141, 0xbb000000, v136
    v_mul_f32 v138, v141, v141
    v_mov_b32 v139, 0x3b000000
    v_fma_f32 v138, v137, v139, -v138
    v_max_f32 v138, 0, v138
    v_add_f32 v138, 0x3727c5ac, v138
    v_rsq_f32 v143, v138
    s_nop 0
    v_and_b32 v156, 0xffff0000, v140
    v_sub_f32 v157, v140, v156
    v_lshrrev_b32 v145, 16, v156
    v_cvt_pk_bf16_f32 v144, v156, v157
    v_and_b32 v156, 0xffff0000, v141
    v_sub_f32 v157, v141, v156
    v_lshrrev_b32 v147, 16, v156
    v_cvt_pk_bf16_f32 v146, v156, v157
    s_lshl_b32 s34, s3, 8
    s_add_u32 s34, s34, 162816
    v_lshl_add_u32 v156, v3, 2, s34
    v_lshl_add_u32 v157, v4, 4, s34
    ds_write_b32 v156, v142
    ds_write_b32 v156, v143 offset:64
    s_waitcnt lgkmcnt(0)
    ds_read_b128 v[148:151], v157
    ds_read_b128 v[152:155], v157 offset:64
    s_waitcnt lgkmcnt(0)
    s_waitcnt vmcnt(14)
    ds_read_b128 v[88:91], v1 offset:30720
    s_waitcnt lgkmcnt(6)
    v_mfma_f32_16x16x32_bf16 v[16:19], v[64:67], a[32:35], v[16:19]
    v_mfma_f32_16x16x32_bf16 v[20:23], v[64:67], a[36:39], v[20:23]
    ds_read_b128 v[92:95], v1 offset:31744
    s_waitcnt lgkmcnt(6)
    v_mfma_f32_16x16x32_bf16 v[24:27], v[68:71], a[32:35], v[24:27]
    v_mfma_f32_16x16x32_bf16 v[28:31], v[68:71], a[36:39], v[28:31]
    ds_read_b128 v[96:99], v1 offset:32768
    s_waitcnt lgkmcnt(6)
    v_mfma_f32_16x16x32_bf16 v[32:35], v[72:75], a[32:35], v[32:35]
    v_mfma_f32_16x16x32_bf16 v[36:39], v[72:75], a[36:39], v[36:39]
    buffer_load_dwordx4 a[96:99], v1, s[8:11], s33 offen offset:0 sc1
    buffer_load_dwordx4 a[100:103], v1, s[8:11], s33 offen offset:1024 sc1
    ds_read_b128 v[100:103], v1 offset:33792
    s_waitcnt lgkmcnt(6)
    v_mfma_f32_16x16x32_bf16 v[40:43], v[76:79], a[32:35], v[40:43]
    v_mfma_f32_16x16x32_bf16 v[44:47], v[76:79], a[36:39], v[44:47]
    ds_read_b128 v[104:107], v1 offset:34816
    s_waitcnt lgkmcnt(6)
    v_mfma_f32_16x16x32_bf16 v[48:51], a[32:35], v[80:83], v[48:51]
    v_mfma_f32_16x16x32_bf16 v[52:55], a[36:39], v[80:83], v[52:55]
    ds_read_b128 v[108:111], v1 offset:35840
    s_waitcnt lgkmcnt(6)
    v_mfma_f32_16x16x32_bf16 v[56:59], a[32:35], v[84:87], v[56:59]
    v_mfma_f32_16x16x32_bf16 v[60:63], a[36:39], v[84:87], v[60:63]
    s_waitcnt vmcnt(14)
    ds_read_b128 v[64:67], v1 offset:36864
    s_waitcnt lgkmcnt(6)
    v_mfma_f32_16x16x32_bf16 v[16:19], v[88:91], a[40:43], v[16:19]
    v_mfma_f32_16x16x32_bf16 v[20:23], v[88:91], a[44:47], v[20:23]
    ds_read_b128 v[68:71], v1 offset:37888
    s_waitcnt lgkmcnt(6)
    v_mfma_f32_16x16x32_bf16 v[24:27], v[92:95], a[40:43], v[24:27]
    v_mfma_f32_16x16x32_bf16 v[28:31], v[92:95], a[44:47], v[28:31]
    ds_read_b128 v[72:75], v1 offset:38912
    s_waitcnt lgkmcnt(6)
    v_mfma_f32_16x16x32_bf16 v[32:35], v[96:99], a[40:43], v[32:35]
    v_mfma_f32_16x16x32_bf16 v[36:39], v[96:99], a[44:47], v[36:39]
    buffer_load_dwordx4 a[104:107], v1, s[8:11], s33 offen offset:2048 sc1
    buffer_load_dwordx4 a[108:111], v1, s[8:11], s33 offen offset:3072 sc1
    s_add_u32 s33, s33, 4096
    ds_read_b128 v[76:79], v1 offset:39936
    s_waitcnt lgkmcnt(6)
    v_mfma_f32_16x16x32_bf16 v[40:43], v[100:103], a[40:43], v[40:43]
    v_mfma_f32_16x16x32_bf16 v[44:47], v[100:103], a[44:47], v[44:47]
    ds_read_b128 v[80:83], v1 offset:40960
    s_waitcnt lgkmcnt(6)
    v_mfma_f32_16x16x32_bf16 v[48:51], a[40:43], v[104:107], v[48:51]
    v_mfma_f32_16x16x32_bf16 v[52:55], a[44:47], v[104:107], v[52:55]
    ds_read_b128 v[84:87], v1 offset:41984
    s_waitcnt lgkmcnt(6)
    v_mfma_f32_16x16x32_bf16 v[56:59], a[40:43], v[108:111], v[56:59]
    v_mfma_f32_16x16x32_bf16 v[60:63], a[44:47], v[108:111], v[60:63]
    s_waitcnt vmcnt(14)
    ds_read_b128 v[88:91], v1 offset:43008
    s_waitcnt lgkmcnt(6)
    v_mfma_f32_16x16x32_bf16 v[16:19], v[64:67], a[48:51], v[16:19]
    v_mfma_f32_16x16x32_bf16 v[20:23], v[64:67], a[52:55], v[20:23]
    ds_read_b128 v[92:95], v1 offset:44032
    s_waitcnt lgkmcnt(6)
    v_mfma_f32_16x16x32_bf16 v[24:27], v[68:71], a[48:51], v[24:27]
    v_mfma_f32_16x16x32_bf16 v[28:31], v[68:71], a[52:55], v[28:31]
    ds_read_b128 v[96:99], v1 offset:45056
    s_waitcnt lgkmcnt(6)
    v_mfma_f32_16x16x32_bf16 v[32:35], v[72:75], a[48:51], v[32:35]
    v_mfma_f32_16x16x32_bf16 v[36:39], v[72:75], a[52:55], v[36:39]
    buffer_load_dwordx4 a[112:115], v1, s[8:11], s33 offen offset:0 sc1
    buffer_load_dwordx4 a[116:119], v1, s[8:11], s33 offen offset:1024 sc1
    ds_read_b128 v[100:103], v1 offset:46080
    s_waitcnt lgkmcnt(6)
    v_mfma_f32_16x16x32_bf16 v[40:43], v[76:79], a[48:51], v[40:43]
    v_mfma_f32_16x16x32_bf16 v[44:47], v[76:79], a[52:55], v[44:47]
    ds_read_b128 v[104:107], v1 offset:47104
    s_waitcnt lgkmcnt(6)
    v_mfma_f32_16x16x32_bf16 v[48:51], a[48:51], v[80:83], v[48:51]
    v_mfma_f32_16x16x32_bf16 v[52:55], a[52:55], v[80:83], v[52:55]
    ds_read_b128 v[108:111], v1 offset:48128
    s_waitcnt lgkmcnt(6)
    v_mfma_f32_16x16x32_bf16 v[56:59], a[48:51], v[84:87], v[56:59]
    v_mfma_f32_16x16x32_bf16 v[60:63], a[52:55], v[84:87], v[60:63]
    s_waitcnt vmcnt(14)
    ds_read_b128 v[64:67], v1 offset:49152
    s_waitcnt lgkmcnt(6)
    v_mfma_f32_16x16x32_bf16 v[16:19], v[88:91], a[56:59], v[16:19]
    v_mfma_f32_16x16x32_bf16 v[20:23], v[88:91], a[60:63], v[20:23]
    ds_read_b128 v[68:71], v1 offset:50176
    s_waitcnt lgkmcnt(6)
    v_mfma_f32_16x16x32_bf16 v[24:27], v[92:95], a[56:59], v[24:27]
    v_mfma_f32_16x16x32_bf16 v[28:31], v[92:95], a[60:63], v[28:31]
    ds_read_b128 v[72:75], v1 offset:51200
    s_waitcnt lgkmcnt(6)
    v_mfma_f32_16x16x32_bf16 v[32:35], v[96:99], a[56:59], v[32:35]
    v_mfma_f32_16x16x32_bf16 v[36:39], v[96:99], a[60:63], v[36:39]
    buffer_load_dwordx4 a[120:123], v1, s[8:11], s33 offen offset:2048 sc1
    buffer_load_dwordx4 a[124:127], v1, s[8:11], s33 offen offset:3072 sc1
    s_add_u32 s33, s33, 4096
    ds_read_b128 v[76:79], v1 offset:52224
    s_waitcnt lgkmcnt(6)
    v_mfma_f32_16x16x32_bf16 v[40:43], v[100:103], a[56:59], v[40:43]
    v_mfma_f32_16x16x32_bf16 v[44:47], v[100:103], a[60:63], v[44:47]
    ds_read_b128 v[80:83], v1 offset:53248
    s_waitcnt lgkmcnt(6)
    v_mfma_f32_16x16x32_bf16 v[48:51], a[56:59], v[104:107], v[48:51]
    v_mfma_f32_16x16x32_bf16 v[52:55], a[60:63], v[104:107], v[52:55]
    ds_read_b128 v[84:87], v1 offset:54272
    s_waitcnt lgkmcnt(6)
    v_mfma_f32_16x16x32_bf16 v[56:59], a[56:59], v[108:111], v[56:59]
    v_mfma_f32_16x16x32_bf16 v[60:63], a[60:63], v[108:111], v[60:63]
    s_waitcnt vmcnt(14)
    ds_read_b128 v[88:91], v1 offset:55296
    s_waitcnt lgkmcnt(6)
    v_mfma_f32_16x16x32_bf16 v[16:19], v[64:67], a[64:67], v[16:19]
    v_mfma_f32_16x16x32_bf16 v[20:23], v[64:67], a[68:71], v[20:23]
    ds_read_b128 v[92:95], v1 offset:56320
    s_waitcnt lgkmcnt(6)
    v_mfma_f32_16x16x32_bf16 v[24:27], v[68:71], a[64:67], v[24:27]
    v_mfma_f32_16x16x32_bf16 v[28:31], v[68:71], a[68:71], v[28:31]
    ds_read_b128 v[96:99], v1 offset:57344
    s_waitcnt lgkmcnt(6)
    v_mfma_f32_16x16x32_bf16 v[32:35], v[72:75], a[64:67], v[32:35]
    v_mfma_f32_16x16x32_bf16 v[36:39], v[72:75], a[68:71], v[36:39]
    ds_read_b128 v[100:103], v1 offset:58368
    s_waitcnt lgkmcnt(6)
    v_mfma_f32_16x16x32_bf16 v[40:43], v[76:79], a[64:67], v[40:43]
    v_mfma_f32_16x16x32_bf16 v[44:47], v[76:79], a[68:71], v[44:47]
    ds_read_b128 v[104:107], v1 offset:59392
    s_waitcnt lgkmcnt(6)
    v_mfma_f32_16x16x32_bf16 v[48:51], a[64:67], v[80:83], v[48:51]
    v_mfma_f32_16x16x32_bf16 v[52:55], a[68:71], v[80:83], v[52:55]
    ds_read_b128 v[108:111], v1 offset:60416
    s_waitcnt lgkmcnt(6)
    v_mfma_f32_16x16x32_bf16 v[56:59], a[64:67], v[84:87], v[56:59]
    v_mfma_f32_16x16x32_bf16 v[60:63], a[68:71], v[84:87], v[60:63]
    v_lshrrev_b32 v160, 1, v4
    v_lshlrev_b32 v160, 9, v160
    v_and_b32 v163, 1, v4
    v_lshl_add_u32 v161, v163, 8, v160
    v_lshl_add_u32 v161, v3, 4, v161
    v_lshrrev_b32 v162, 2, v3
    v_lshlrev_b32 v162, 3, v162
    v_lshl_add_u32 v162, v163, 2, v162
    v_and_b32 v163, 3, v3
    v_add_u32 v162, v162, v163
    v_lshl_add_u32 v162, v162, 4, v160
    v_mul_f32 v140, 0x3eb8aa3b, v142
    v_mul_f32 v141, 0x3eb8aa3b, v143
    s_lshl_b32 s31, s17, 7
    s_add_u32 s31, s31, s30
    s_lshl_b32 s31, s31, 10
    s_add_u32 s31, s31, s24
    s_waitcnt vmcnt(12)
    ds_read_b128 v[64:67], v1 offset:61440
    s_waitcnt lgkmcnt(6)
    v_mfma_f32_16x16x32_bf16 v[16:19], v[88:91], a[72:75], v[16:19]
    v_mfma_f32_16x16x32_bf16 v[20:23], v[88:91], a[76:79], v[20:23]
    ds_read_b128 v[68:71], v1 offset:62464
    s_waitcnt lgkmcnt(6)
    v_mfma_f32_16x16x32_bf16 v[24:27], v[92:95], a[72:75], v[24:27]
    v_mfma_f32_16x16x32_bf16 v[28:31], v[92:95], a[76:79], v[28:31]
    ds_read_b128 v[72:75], v1 offset:63488
    s_waitcnt lgkmcnt(6)
    v_mfma_f32_16x16x32_bf16 v[32:35], v[96:99], a[72:75], v[32:35]
    v_mfma_f32_16x16x32_bf16 v[36:39], v[96:99], a[76:79], v[36:39]
    ds_read_b128 v[76:79], v1 offset:64512
    s_waitcnt lgkmcnt(6)
    v_mfma_f32_16x16x32_bf16 v[40:43], v[100:103], a[72:75], v[40:43]
    v_mfma_f32_16x16x32_bf16 v[44:47], v[100:103], a[76:79], v[44:47]
    ds_read_b128 v[80:83], v14 offset:0
    s_waitcnt lgkmcnt(6)
    v_mfma_f32_16x16x32_bf16 v[48:51], a[72:75], v[104:107], v[48:51]
    v_mfma_f32_16x16x32_bf16 v[52:55], a[76:79], v[104:107], v[52:55]
    ds_read_b128 v[84:87], v14 offset:1024
    s_waitcnt lgkmcnt(6)
    v_mfma_f32_16x16x32_bf16 v[56:59], a[72:75], v[108:111], v[56:59]
    v_mfma_f32_16x16x32_bf16 v[60:63], a[76:79], v[108:111], v[60:63]
    s_waitcnt vmcnt(10)
    ds_read_b128 v[88:91], v14 offset:2048
    s_waitcnt lgkmcnt(6)
    v_mfma_f32_16x16x32_bf16 v[16:19], v[64:67], a[80:83], v[16:19]
    v_mfma_f32_16x16x32_bf16 v[20:23], v[64:67], a[84:87], v[20:23]
    ds_read_b128 v[92:95], v14 offset:3072
    s_waitcnt lgkmcnt(6)
    v_mfma_f32_16x16x32_bf16 v[24:27], v[68:71], a[80:83], v[24:27]
    v_mfma_f32_16x16x32_bf16 v[28:31], v[68:71], a[84:87], v[28:31]
    ds_read_b128 v[96:99], v14 offset:4096
    s_waitcnt lgkmcnt(6)
    v_mfma_f32_16x16x32_bf16 v[32:35], v[72:75], a[80:83], v[32:35]
    v_mfma_f32_16x16x32_bf16 v[36:39], v[72:75], a[84:87], v[36:39]
    ds_read_b128 v[100:103], v14 offset:5120
    s_waitcnt lgkmcnt(6)
    v_mfma_f32_16x16x32_bf16 v[40:43], v[76:79], a[80:83], v[40:43]
    v_mfma_f32_16x16x32_bf16 v[44:47], v[76:79], a[84:87], v[44:47]
    ds_read_b128 v[104:107], v14 offset:6144
    s_waitcnt lgkmcnt(6)
    v_mfma_f32_16x16x32_bf16 v[48:51], a[80:83], v[80:83], v[48:51]
    v_mfma_f32_16x16x32_bf16 v[52:55], a[84:87], v[80:83], v[52:55]
    ds_read_b128 v[108:111], v14 offset:7168
    s_waitcnt lgkmcnt(6)
    v_mfma_f32_16x16x32_bf16 v[56:59], a[80:83], v[84:87], v[56:59]
    v_mfma_f32_16x16x32_bf16 v[60:63], a[84:87], v[84:87], v[60:63]
    s_waitcnt vmcnt(8)
    ds_read_b128 v[64:67], v14 offset:8192
    s_waitcnt lgkmcnt(6)
    v_mfma_f32_16x16x32_bf16 v[16:19], v[88:91], a[88:91], v[16:19]
    v_mfma_f32_16x16x32_bf16 v[20:23], v[88:91], a[92:95], v[20:23]
    ds_read_b128 v[68:71], v14 offset:9216
    s_waitcnt lgkmcnt(6)
    v_mfma_f32_16x16x32_bf16 v[24:27], v[92:95], a[88:91], v[24:27]
    v_mfma_f32_16x16x32_bf16 v[28:31], v[92:95], a[92:95], v[28:31]
    ds_read_b128 v[72:75], v14 offset:10240
    s_waitcnt lgkmcnt(6)
    v_mfma_f32_16x16x32_bf16 v[32:35], v[96:99], a[88:91], v[32:35]
    v_mfma_f32_16x16x32_bf16 v[36:39], v[96:99], a[92:95], v[36:39]
    ds_read_b128 v[76:79], v14 offset:11264
    s_waitcnt lgkmcnt(6)
    v_mfma_f32_16x16x32_bf16 v[40:43], v[100:103], a[88:91], v[40:43]
    v_mfma_f32_16x16x32_bf16 v[44:47], v[100:103], a[92:95], v[44:47]
    ds_read_b128 v[80:83], v14 offset:12288
    s_waitcnt lgkmcnt(6)
    v_mfma_f32_16x16x32_bf16 v[48:51], a[88:91], v[104:107], v[48:51]
    v_mfma_f32_16x16x32_bf16 v[52:55], a[92:95], v[104:107], v[52:55]
    ds_read_b128 v[84:87], v14 offset:13312
    s_waitcnt lgkmcnt(6)
    v_mfma_f32_16x16x32_bf16 v[56:59], a[88:91], v[108:111], v[56:59]
    v_mfma_f32_16x16x32_bf16 v[60:63], a[92:95], v[108:111], v[60:63]
    s_waitcnt vmcnt(6)
    ds_read_b128 v[88:91], v14 offset:14336
    s_waitcnt lgkmcnt(6)
    v_mfma_f32_16x16x32_bf16 v[16:19], v[64:67], a[96:99], v[16:19]
    v_mfma_f32_16x16x32_bf16 v[20:23], v[64:67], a[100:103], v[20:23]
    ds_read_b128 v[92:95], v14 offset:15360
    s_waitcnt lgkmcnt(6)
    v_mfma_f32_16x16x32_bf16 v[24:27], v[68:71], a[96:99], v[24:27]
    v_mfma_f32_16x16x32_bf16 v[28:31], v[68:71], a[100:103], v[28:31]
    ds_read_b128 v[96:99], v14 offset:16384
    s_waitcnt lgkmcnt(6)
    v_mfma_f32_16x16x32_bf16 v[32:35], v[72:75], a[96:99], v[32:35]
    v_mfma_f32_16x16x32_bf16 v[36:39], v[72:75], a[100:103], v[36:39]
    ds_read_b128 v[100:103], v14 offset:17408
    s_waitcnt lgkmcnt(6)
    v_mfma_f32_16x16x32_bf16 v[40:43], v[76:79], a[96:99], v[40:43]
    v_mfma_f32_16x16x32_bf16 v[44:47], v[76:79], a[100:103], v[44:47]
    ds_read_b128 v[104:107], v14 offset:18432
    s_waitcnt lgkmcnt(6)
    v_mfma_f32_16x16x32_bf16 v[48:51], a[96:99], v[80:83], v[48:51]
    v_mfma_f32_16x16x32_bf16 v[52:55], a[100:103], v[80:83], v[52:55]
    ds_read_b128 v[108:111], v14 offset:19456
    s_waitcnt lgkmcnt(6)
    v_mfma_f32_16x16x32_bf16 v[56:59], a[96:99], v[84:87], v[56:59]
    v_mfma_f32_16x16x32_bf16 v[60:63], a[100:103], v[84:87], v[60:63]
    s_waitcnt vmcnt(4)
    ds_read_b128 v[64:67], v14 offset:20480
    s_waitcnt lgkmcnt(6)
    v_mfma_f32_16x16x32_bf16 v[16:19], v[88:91], a[104:107], v[16:19]
    v_mfma_f32_16x16x32_bf16 v[20:23], v[88:91], a[108:111], v[20:23]
    ds_read_b128 v[68:71], v14 offset:21504
    s_waitcnt lgkmcnt(6)
    v_mfma_f32_16x16x32_bf16 v[24:27], v[92:95], a[104:107], v[24:27]
    v_mfma_f32_16x16x32_bf16 v[28:31], v[92:95], a[108:111], v[28:31]
    ds_read_b128 v[72:75], v14 offset:22528
    s_waitcnt lgkmcnt(6)
    v_mfma_f32_16x16x32_bf16 v[32:35], v[96:99], a[104:107], v[32:35]
    v_mfma_f32_16x16x32_bf16 v[36:39], v[96:99], a[108:111], v[36:39]
    ds_read_b128 v[76:79], v14 offset:23552
    s_waitcnt lgkmcnt(6)
    v_mfma_f32_16x16x32_bf16 v[40:43], v[100:103], a[104:107], v[40:43]
    v_mfma_f32_16x16x32_bf16 v[44:47], v[100:103], a[108:111], v[44:47]
    ds_read_b128 v[80:83], v14 offset:24576
    s_waitcnt lgkmcnt(6)
    v_mfma_f32_16x16x32_bf16 v[48:51], a[104:107], v[104:107], v[48:51]
    v_mfma_f32_16x16x32_bf16 v[52:55], a[108:111], v[104:107], v[52:55]
    ds_read_b128 v[84:87], v14 offset:25600
    s_waitcnt lgkmcnt(6)
    v_mfma_f32_16x16x32_bf16 v[56:59], a[104:107], v[108:111], v[56:59]
    v_mfma_f32_16x16x32_bf16 v[60:63], a[108:111], v[108:111], v[60:63]
    s_waitcnt vmcnt(2)
    ds_read_b128 v[88:91], v14 offset:26624
    s_waitcnt lgkmcnt(6)
    v_mfma_f32_16x16x32_bf16 v[16:19], v[64:67], a[112:115], v[16:19]
    v_mfma_f32_16x16x32_bf16 v[20:23], v[64:67], a[116:119], v[20:23]
    ds_read_b128 v[92:95], v14 offset:27648
    s_waitcnt lgkmcnt(6)
    v_mfma_f32_16x16x32_bf16 v[24:27], v[68:71], a[112:115], v[24:27]
    v_mfma_f32_16x16x32_bf16 v[28:31], v[68:71], a[116:119], v[28:31]
    ds_read_b128 v[96:99], v14 offset:28672
    s_waitcnt lgkmcnt(6)
    v_mfma_f32_16x16x32_bf16 v[32:35], v[72:75], a[112:115], v[32:35]
    v_mfma_f32_16x16x32_bf16 v[36:39], v[72:75], a[116:119], v[36:39]
    ds_read_b128 v[100:103], v14 offset:29696
    s_waitcnt lgkmcnt(6)
    v_mfma_f32_16x16x32_bf16 v[40:43], v[76:79], a[112:115], v[40:43]
    v_mfma_f32_16x16x32_bf16 v[44:47], v[76:79], a[116:119], v[44:47]
    ds_read_b128 v[104:107], v14 offset:30720
    s_waitcnt lgkmcnt(6)
    v_mfma_f32_16x16x32_bf16 v[48:51], a[112:115], v[80:83], v[48:51]
    v_mfma_f32_16x16x32_bf16 v[52:55], a[116:119], v[80:83], v[52:55]
    ds_read_b128 v[108:111], v14 offset:31744
    s_waitcnt lgkmcnt(6)
    v_mfma_f32_16x16x32_bf16 v[56:59], a[112:115], v[84:87], v[56:59]
    v_mfma_f32_16x16x32_bf16 v[60:63], a[116:119], v[84:87], v[60:63]
    s_waitcnt vmcnt(0)
    s_waitcnt lgkmcnt(5)
    v_mfma_f32_16x16x32_bf16 v[16:19], v[88:91], a[120:123], v[16:19]
    v_mfma_f32_16x16x32_bf16 v[20:23], v[88:91], a[124:127], v[20:23]
    s_waitcnt lgkmcnt(4)
    v_mfma_f32_16x16x32_bf16 v[24:27], v[92:95], a[120:123], v[24:27]
    v_mfma_f32_16x16x32_bf16 v[28:31], v[92:95], a[124:127], v[28:31]
    s_waitcnt lgkmcnt(3)
    v_mfma_f32_16x16x32_bf16 v[32:35], v[96:99], a[120:123], v[32:35]
    v_mfma_f32_16x16x32_bf16 v[36:39], v[96:99], a[124:127], v[36:39]
    s_waitcnt lgkmcnt(2)
    v_mfma_f32_16x16x32_bf16 v[40:43], v[100:103], a[120:123], v[40:43]
    v_mfma_f32_16x16x32_bf16 v[44:47], v[100:103], a[124:127], v[44:47]
    s_waitcnt lgkmcnt(1)
    v_mfma_f32_16x16x32_bf16 v[48:51], a[120:123], v[104:107], v[48:51]
    v_mfma_f32_16x16x32_bf16 v[52:55], a[124:127], v[104:107], v[52:55]
    s_waitcnt lgkmcnt(0)
    v_mfma_f32_16x16x32_bf16 v[56:59], a[120:123], v[108:111], v[56:59]
    v_mfma_f32_16x16x32_bf16 v[60:63], a[124:127], v[108:111], v[60:63]
    v_mfma_f32_16x16x16_bf16 v[32:35], v[116:117], v[144:145], v[32:35]
    v_mfma_f32_16x16x16_bf16 v[36:39], v[116:117], v[146:147], v[36:39]
    v_mfma_f32_16x16x16_bf16 v[40:43], v[118:119], v[144:145], v[40:43]
    v_mfma_f32_16x16x16_bf16 v[44:47], v[118:119], v[146:147], v[44:47]
    v_mfma_f32_16x16x16_bf16 v[48:51], v[144:145], v[120:121], v[48:51]
    v_mfma_f32_16x16x16_bf16 v[52:55], v[146:147], v[120:121], v[52:55]
    v_mfma_f32_16x16x16_bf16 v[56:59], v[144:145], v[122:123], v[56:59]
    v_mfma_f32_16x16x16_bf16 v[60:63], v[146:147], v[122:123], v[60:63]
    v_mfma_f32_16x16x16_bf16 v[16:19], v[112:113], v[144:145], v[16:19]
    v_mfma_f32_16x16x16_bf16 v[20:23], v[112:113], v[146:147], v[20:23]
    v_mfma_f32_16x16x16_bf16 v[24:27], v[114:115], v[144:145], v[24:27]
    v_mfma_f32_16x16x16_bf16 v[28:31], v[114:115], v[146:147], v[28:31]
    s_add_u32 s32, s31, 0xe00000
    v_mul_f32 v32, v142, v32
    v_mul_f32 v33, v142, v33
    v_mul_f32 v34, v142, v34
    v_mul_f32 v35, v142, v35
    v_mul_f32 v36, v143, v36
    v_mul_f32 v37, v143, v37
    v_mul_f32 v38, v143, v38
    v_mul_f32 v39, v143, v39
    v_cvt_pk_bf16_f32 v72, v32, v33
    v_cvt_pk_bf16_f32 v73, v34, v35
    v_cvt_pk_bf16_f32 v74, v36, v37
    v_cvt_pk_bf16_f32 v75, v38, v39
    s_nop 1
    v_permlane16_swap_b32 v72, v74
    v_permlane16_swap_b32 v73, v75
    buffer_store_dwordx4 v[72:75], v162, s[8:11], s32 offen sc1
    s_add_u32 s32, s31, 0xe10000
    v_mul_f32 v40, v142, v40
    v_mul_f32 v41, v142, v41
    v_mul_f32 v42, v142, v42
    v_mul_f32 v43, v142, v43
    v_mul_f32 v44, v143, v44
    v_mul_f32 v45, v143, v45
    v_mul_f32 v46, v143, v46
    v_mul_f32 v47, v143, v47
    v_cvt_pk_bf16_f32 v76, v40, v41
    v_cvt_pk_bf16_f32 v77, v42, v43
    v_cvt_pk_bf16_f32 v78, v44, v45
    v_cvt_pk_bf16_f32 v79, v46, v47
    s_nop 1
    v_permlane16_swap_b32 v76, v78
    v_permlane16_swap_b32 v77, v79
    buffer_store_dwordx4 v[76:79], v162, s[8:11], s32 offen sc1
    s_add_u32 s32, s31, 0x1000000
    v_mul_f32 v48, v148, v48
    v_mul_f32 v49, v149, v49
    v_mul_f32 v50, v150, v50
    v_mul_f32 v51, v151, v51
    v_mul_f32 v52, v152, v52
    v_mul_f32 v53, v153, v53
    v_mul_f32 v54, v154, v54
    v_mul_f32 v55, v155, v55
    v_cvt_pk_bf16_f32 v80, v48, v49
    v_cvt_pk_bf16_f32 v81, v50, v51
    v_cvt_pk_bf16_f32 v82, v52, v53
    v_cvt_pk_bf16_f32 v83, v54, v55
    buffer_store_dwordx4 v[80:83], v1, s[8:11], s32 offen sc1
    s_add_u32 s32, s31, 0x1010000
    v_mul_f32 v56, v148, v56
    v_mul_f32 v57, v149, v57
    v_mul_f32 v58, v150, v58
    v_mul_f32 v59, v151, v59
    v_mul_f32 v60, v152, v60
    v_mul_f32 v61, v153, v61
    v_mul_f32 v62, v154, v62
    v_mul_f32 v63, v155, v63
    v_cvt_pk_bf16_f32 v84, v56, v57
    v_cvt_pk_bf16_f32 v85, v58, v59
    v_cvt_pk_bf16_f32 v86, v60, v61
    v_cvt_pk_bf16_f32 v87, v62, v63
    buffer_store_dwordx4 v[84:87], v1, s[8:11], s32 offen sc1
    s_add_u32 s32, s31, 0xc00000
    s_nop 3
    v_mul_f32 v16, v140, v16
    v_mul_f32 v17, v140, v17
    v_mul_f32 v18, v140, v18
    v_mul_f32 v19, v140, v19
    v_mul_f32 v20, v141, v20
    v_mul_f32 v21, v141, v21
    v_mul_f32 v22, v141, v22
    v_mul_f32 v23, v141, v23
    v_cvt_pk_bf16_f32 v64, v16, v17
    v_cvt_pk_bf16_f32 v65, v18, v19
    v_cvt_pk_bf16_f32 v66, v20, v21
    v_cvt_pk_bf16_f32 v67, v22, v23
    s_nop 1
    v_permlane16_swap_b32 v64, v66
    v_permlane16_swap_b32 v65, v67
    buffer_store_dwordx4 v[64:67], v161, s[8:11], s32 offen sc1
    s_add_u32 s32, s31, 0xc10000
    s_nop 3
    v_mul_f32 v24, v140, v24
    v_mul_f32 v25, v140, v25
    v_mul_f32 v26, v140, v26
    v_mul_f32 v27, v140, v27
    v_mul_f32 v28, v141, v28
    v_mul_f32 v29, v141, v29
    v_mul_f32 v30, v141, v30
    v_mul_f32 v31, v141, v31
    v_cvt_pk_bf16_f32 v68, v24, v25
    v_cvt_pk_bf16_f32 v69, v26, v27
    v_cvt_pk_bf16_f32 v70, v28, v29
    v_cvt_pk_bf16_f32 v71, v30, v31
    s_nop 1
    v_permlane16_swap_b32 v68, v70
    v_permlane16_swap_b32 v69, v71
    buffer_store_dwordx4 v[68:71], v161, s[8:11], s32 offen sc1
    s_lshl_b32 s40, s17, 8
    s_lshl_b32 s41, s16, 2
    s_add_u32 s40, s40, s41
    s_add_u32 s40, s40, s26
    s_add_u32 s40, s40, 0
    v_mov_b32 v6, 1
    v_mov_b32 v7, 0
    s_waitcnt vmcnt(0)
    s_barrier
    s_cmp_lg_u32 s3, 0
    s_cbranch_scc1 LSG_1
    s_mov_b64 exec, 1
    buffer_store_dword v6, v7, s[8:11], s40 offen sc1
    s_mov_b64 exec, -1
LSG_1:
    v_and_b32 v24, 31, v2
    v_lshrrev_b32 v25, 1, v24
    s_lshl_b32 s30, s3, 4
    v_add_u32 v25, s30, v25
    v_mul_u32_u24 v25, 1056, v25
    v_and_b32 v28, 1, v2
    v_lshl_add_u32 v25, v28, 4, v25
    v_add_u32 v25, 66560, v25
    v_mul_u32_u24 v28, 0x3f80, v28
    v_lshl_or_b32 v28, v28, 16, v28
    v_mov_b32 v29, v28
    v_mov_b32 v30, v28
    v_mov_b32 v31, v28
    ds_write_b128 v25, v[28:31]
    v_lshrrev_b32 v32, 5, v2
    v_lshlrev_b32 v33, 8, v32
    v_lshl_add_u32 v33, v24, 4, v33
    v_add_u32 v33, 65536, v33
    v_and_b32 v34, 27, v24
    v_cmp_eq_u32 vcc, 16, v34
    v_mov_b32 v34, 66560
    v_mov_b32 v35, 66576
    v_cndmask_b32 v34, v34, v35, vcc
    v_cmp_gt_u32 vcc, 16, v24
    v_subrev_u32 v35, 0x200, v34
    s_nop 0
    v_cndmask_b32 v204, v34, v33, vcc
    v_cndmask_b32 v205, v35, v33, vcc
    v_mov_b32 v200, 0xdddddddd
    s_lshr_b32 s35, s18, 1
    v_mov_b32 v168, 0
    v_mov_b32 v184, 0
    v_mov_b32 v120, 0
    v_mov_b32 v169, 0
    v_mov_b32 v185, 0
    v_mov_b32 v121, 0
    v_mov_b32 v170, 0
    v_mov_b32 v186, 0
    v_mov_b32 v122, 0
    v_mov_b32 v171, 0
    v_mov_b32 v187, 0
    v_mov_b32 v123, 0
    v_mov_b32 v172, 0
    v_mov_b32 v188, 0
    v_mov_b32 v124, 0
    v_mov_b32 v173, 0
    v_mov_b32 v189, 0
    v_mov_b32 v125, 0
    v_mov_b32 v174, 0
    v_mov_b32 v190, 0
    v_mov_b32 v126, 0
    v_mov_b32 v175, 0
    v_mov_b32 v191, 0
    v_mov_b32 v127, 0
    v_mov_b32 v176, 0
    v_mov_b32 v192, 0
    v_mov_b32 v128, 0
    v_mov_b32 v177, 0
    v_mov_b32 v193, 0
    v_mov_b32 v129, 0
    v_mov_b32 v178, 0
    v_mov_b32 v194, 0
    v_mov_b32 v130, 0
    v_mov_b32 v179, 0
    v_mov_b32 v195, 0
    v_mov_b32 v131, 0
    v_mov_b32 v180, 0
    v_mov_b32 v196, 0
    v_mov_b32 v132, 0
    v_mov_b32 v181, 0
    v_mov_b32 v197, 0
    v_mov_b32 v133, 0
    v_mov_b32 v182, 0
    v_mov_b32 v198, 0
    v_mov_b32 v134, 0
    v_mov_b32 v183, 0
    v_mov_b32 v199, 0
    v_mov_b32 v135, 0
    s_lshl_b32 s30, s18, 16
    s_add_u32 s30, s30, s24
    s_lshl_b32 s31, s19, 3
    s_lshl_b32 s32, s3, 1
    s_add_u32 s31, s31, s32
    s_lshl_b32 s31, s31, 10
    s_add_u32 s31, s31, s30
    s_add_u32 s31, s31, 0xc00000
    s_lshl_b32 s32, s3, 10
    s_mul_i32 s33, s3, 1056
    s_add_u32 s33, s33, 65536
    s_add_u32 s36, s30, s32
    s_add_u32 s37, s36, 0x1000000
    s_add_u32 s36, s36, 0xe00000
    s_lshl_b32 s56, s21, 4
    s_lshl_b32 s57, s3, 2
    s_add_u32 s56, s56, s57
    s_lshl_b32 s56, s56, 12
    s_add_u32 s56, s56, 0x200000
    s_mul_i32 s54, s21, 56
    s_mul_i32 s55, s3, 14
    s_add_u32 s54, s54, s55
    s_lshl_b32 s54, s54, 12
    s_add_u32 s54, s54, 0x700000
    s_mul_i32 s50, s23, 229376
    s_add_u32 s50, s50, 0x300000
    s_lshl_b32 s51, s3, 13
    s_add_u32 s50, s50, s51
    buffer_load_dwordx4 a[0:3], v1, s[8:11], s56 offen offset:0
    buffer_load_dwordx4 a[4:7], v1, s[8:11], s56 offen offset:1024
    buffer_load_dwordx4 a[8:11], v1, s[8:11], s56 offen offset:2048
    buffer_load_dwordx4 a[12:15], v1, s[8:11], s56 offen offset:3072
    s_add_u32 s56, s56, 4096
    buffer_load_dwordx4 a[16:19], v1, s[8:11], s56 offen offset:0
    buffer_load_dwordx4 a[20:23], v1, s[8:11], s56 offen offset:1024
    buffer_load_dwordx4 a[24:27], v1, s[8:11], s56 offen offset:2048
    buffer_load_dwordx4 a[28:31], v1, s[8:11], s56 offen offset:3072
    s_add_u32 s56, s56, 4096
    buffer_load_dwordx4 a[32:35], v1, s[8:11], s56 offen offset:0
    buffer_load_dwordx4 a[36:39], v1, s[8:11], s56 offen offset:1024
    buffer_load_dwordx4 a[40:43], v1, s[8:11], s56 offen offset:2048
    buffer_load_dwordx4 a[44:47], v1, s[8:11], s56 offen offset:3072
    s_add_u32 s56, s56, 4096
    buffer_load_dwordx4 a[48:51], v1, s[8:11], s56 offen offset:0
    buffer_load_dwordx4 a[52:55], v1, s[8:11], s56 offen offset:1024
    buffer_load_dwordx4 a[56:59], v1, s[8:11], s56 offen offset:2048
    buffer_load_dwordx4 a[60:63], v1, s[8:11], s56 offen offset:3072
    s_add_u32 s56, s56, 4096
    s_cmp_lg_u32 s3, 0
    s_cbranch_scc1 LPO_2
    s_lshl_b32 s40, s35, 8
    s_add_u32 s40, s40, s26
    s_add_u32 s40, s40, 0
    s_mov_b32 s42, 0xffff
    s_mov_b32 s43, 0
    s_mov_b64 exec, s[42:43]
    s_mov_b32 s41, 0
LPL_2:
    buffer_load_dword v6, v5, s[8:11], s40 offen sc1
    s_add_u32 s41, s41, 1
    s_waitcnt vmcnt(0)
    v_cmp_ne_u32 vcc, 1, v6
    s_cmp_gt_u32 s41, 100000
    s_cbranch_scc1 LPX_2
    s_nop 2
    s_cbranch_vccnz LPL_2
LPX_2:
    s_mov_b64 exec, -1
LPO_2:
    s_barrier
    buffer_load_dwordx4 v[16:19], v1, s[8:11], s31 offen sc1
    buffer_load_dwordx4 v[20:23], v1, s[8:11], s31 offen offset:1024 sc1
    s_mov_b32 m0, s32
    s_add_u32 s32, s32, 4096
    buffer_load_dwordx4 v1, s[8:11], s36 offen sc1 lds
    s_mov_b32 m0, s33
    s_add_u32 s33, s33, 4224
    buffer_load_dwordx4 v1, s[8:11], s37 offen sc1 lds
    s_add_u32 s36, s36, 4096
    s_add_u32 s37, s37, 4096
    s_mov_b32 m0, s32
    s_add_u32 s32, s32, 4096
    buffer_load_dwordx4 v1, s[8:11], s36 offen sc1 lds
    s_mov_b32 m0, s33
    s_add_u32 s33, s33, 4224
    buffer_load_dwordx4 v1, s[8:11], s37 offen sc1 lds
    s_add_u32 s36, s36, 4096
    s_add_u32 s37, s37, 4096
    s_mov_b32 m0, s32
    s_add_u32 s32, s32, 4096
    buffer_load_dwordx4 v1, s[8:11], s36 offen sc1 lds
    s_mov_b32 m0, s33
    s_add_u32 s33, s33, 4224
    buffer_load_dwordx4 v1, s[8:11], s37 offen sc1 lds
    s_add_u32 s36, s36, 4096
    s_add_u32 s37, s37, 4096
    s_mov_b32 s39, 0
    s_waitcnt vmcnt(4)
    s_waitcnt lgkmcnt(0)
    s_barrier
    ds_read_b128 v[24:27], v1
    s_waitcnt lgkmcnt(0)
    v_mfma_f32_32x32x16_bf16 v[72:87], v[24:27], v[16:19], 0
    v_mfma_f32_32x32x16_bf16 v[88:103], v[24:27], v[20:23], 0
    s_nop 12
    v_max3_f32 v206, v72, v73, v74
    v_max3_f32 v206, v206, v75, v76
    v_max3_f32 v206, v206, v77, v78
    v_max3_f32 v206, v206, v79, v80
    v_max3_f32 v206, v206, v81, v82
    v_max3_f32 v206, v206, v83, v84
    v_max3_f32 v206, v206, v85, v86
    v_max_f32 v206, v206, v87
    s_nop 3
    v_max3_f32 v207, v88, v89, v90
    v_max3_f32 v207, v207, v91, v92
    v_max3_f32 v207, v207, v93, v94
    v_max3_f32 v207, v207, v95, v96
    v_max3_f32 v207, v207, v97, v98
    v_max3_f32 v207, v207, v99, v100
    v_max3_f32 v207, v207, v101, v102
    v_max_f32 v207, v207, v103
LA_restart:
    v_mov_b32 v208, v206
    v_mov_b32 v209, v207
    s_nop 1
    v_permlane32_swap_b32 v206, v208
    v_permlane32_swap_b32 v207, v209
    s_nop 1
    v_max_f32 v206, v206, v208
    v_max_f32 v207, v207, v209
    v_mov_b32 v201, v1
    v_mov_b32 v202, v204
    v_mov_b32 v203, v205
    ds_read_b128 v[24:27], v201 offset:0
    ds_read_b128 v[28:31], v201 offset:1024
    ds_read_b128 v[40:43], v202
    ds_read_b128 v[44:47], v203 offset:512
    ds_read_b128 v[68:71], v203 offset:512
    v_sub_f32 v136, 0, v206
    v_sub_f32 v137, 0, v206
    v_sub_f32 v138, 0, v206
    v_sub_f32 v139, 0, v206
    v_sub_f32 v140, 0, v206
    v_sub_f32 v141, 0, v206
    v_sub_f32 v142, 0, v206
    v_sub_f32 v143, 0, v206
    v_sub_f32 v144, 0, v206
    v_sub_f32 v145, 0, v206
    v_sub_f32 v146, 0, v206
    v_sub_f32 v147, 0, v206
    v_sub_f32 v148, 0, v206
    v_sub_f32 v149, 0, v206
    v_sub_f32 v150, 0, v206
    v_sub_f32 v151, 0, v206
    s_waitcnt lgkmcnt(0)
    s_nop 0
    v_mfma_f32_32x32x16_bf16 v[72:87], v[24:27], v[16:19], v[136:151]
    v_sub_f32 v152, 0, v207
    v_sub_f32 v153, 0, v207
    v_sub_f32 v154, 0, v207
    v_sub_f32 v155, 0, v207
    v_sub_f32 v156, 0, v207
    v_sub_f32 v157, 0, v207
    v_sub_f32 v158, 0, v207
    v_sub_f32 v159, 0, v207
    v_sub_f32 v160, 0, v207
    v_sub_f32 v161, 0, v207
    v_sub_f32 v162, 0, v207
    v_sub_f32 v163, 0, v207
    v_sub_f32 v164, 0, v207
    v_sub_f32 v165, 0, v207
    v_sub_f32 v166, 0, v207
    v_sub_f32 v167, 0, v207
    s_nop 1
    v_mfma_f32_32x32x16_bf16 v[88:103], v[24:27], v[20:23], v[152:167]
    s_mov_b32 s38, 8
    s_cmp_lg_u32 s39, 0
    s_cbranch_scc1 LA_loop
    v_exp_f32 v72, v72
    v_exp_f32 v73, v73
    v_exp_f32 v74, v74
    v_exp_f32 v75, v75
    v_smfmac_f32_32x32x32_bf16 v[184:199], v[68:71], v[128:135], v200
    s_waitcnt lgkmcnt(0)
    ds_read_b128 v[32:35], v201 offset:2048
    ds_read_b128 v[48:51], v202 offset:1056
    ds_read_b128 v[52:55], v203 offset:1568
    v_exp_f32 v76, v76
    v_exp_f32 v77, v77
    v_exp_f32 v78, v78
    v_exp_f32 v79, v79
    v_exp_f32 v80, v80
    v_exp_f32 v81, v81
    v_mfma_f32_32x32x16_bf16 v[104:119], v[28:31], v[16:19], v[136:151]
    s_mov_b32 m0, s32
    s_add_u32 s32, s32, 4096
    buffer_load_dwordx4 v1, s[8:11], s36 offen sc1 lds
    s_mov_b32 m0, s33
    s_add_u32 s33, s33, 4224
    buffer_load_dwordx4 v1, s[8:11], s37 offen sc1 lds
    s_add_u32 s36, s36, 4096
    s_add_u32 s37, s37, 4096
    v_exp_f32 v82, v82
    v_exp_f32 v83, v83
    v_exp_f32 v84, v84
    v_exp_f32 v85, v85
    v_smfmac_f32_32x32x32_bf16 v[168:183], v[40:43], v[72:79], v200
    v_exp_f32 v86, v86
    v_exp_f32 v87, v87
    v_exp_f32 v88, v88
    v_exp_f32 v89, v89
    v_exp_f32 v90, v90
    v_exp_f32 v91, v91
    v_smfmac_f32_32x32x32_bf16 v[168:183], v[44:47], v[80:87], v200
    v_exp_f32 v92, v92
    v_exp_f32 v93, v93
    v_exp_f32 v94, v94
    v_exp_f32 v95, v95
    v_exp_f32 v96, v96
    v_exp_f32 v97, v97
    v_mfma_f32_32x32x16_bf16 v[120:135], v[28:31], v[20:23], v[152:167]
    s_mov_b32 m0, s32
    s_add_u32 s32, s32, 4096
    buffer_load_dwordx4 v1, s[8:11], s36 offen sc1 lds
    s_mov_b32 m0, s33
    s_add_u32 s33, s33, 4224
    buffer_load_dwordx4 v1, s[8:11], s37 offen sc1 lds
    s_add_u32 s36, s36, 4096
    s_add_u32 s37, s37, 4096
    v_exp_f32 v98, v98
    v_exp_f32 v99, v99
    v_exp_f32 v100, v100
    v_exp_f32 v101, v101
    v_smfmac_f32_32x32x32_bf16 v[184:199], v[40:43], v[88:95], v200
    v_exp_f32 v102, v102
    v_exp_f32 v103, v103
    v_exp_f32 v104, v104
    v_exp_f32 v105, v105
    v_exp_f32 v106, v106
    v_exp_f32 v107, v107
    v_smfmac_f32_32x32x32_bf16 v[184:199], v[44:47], v[96:103], v200
    s_waitcnt vmcnt(4)
    s_barrier
    s_waitcnt lgkmcnt(0)
    ds_read_b128 v[36:39], v201 offset:3072
    ds_read_b128 v[56:59], v202 offset:2112
    ds_read_b128 v[60:63], v203 offset:2624
    v_exp_f32 v108, v108
    v_exp_f32 v109, v109
    v_exp_f32 v110, v110
    v_exp_f32 v111, v111
    v_exp_f32 v112, v112
    v_exp_f32 v113, v113
    v_mfma_f32_32x32x16_bf16 v[72:87], v[32:35], v[16:19], v[136:151]
    s_mov_b32 m0, s32
    s_add_u32 s32, s32, 4096
    buffer_load_dwordx4 v1, s[8:11], s36 offen sc1 lds
    s_mov_b32 m0, s33
    s_add_u32 s33, s33, 4224
    buffer_load_dwordx4 v1, s[8:11], s37 offen sc1 lds
    s_add_u32 s36, s36, 4096
    s_add_u32 s37, s37, 4096
    v_exp_f32 v114, v114
    v_exp_f32 v115, v115
    v_exp_f32 v116, v116
    v_exp_f32 v117, v117
    v_smfmac_f32_32x32x32_bf16 v[168:183], v[48:51], v[104:111], v200
    v_exp_f32 v118, v118
    v_exp_f32 v119, v119
    v_exp_f32 v120, v120
    v_exp_f32 v121, v121
    v_exp_f32 v122, v122
    v_exp_f32 v123, v123
    v_smfmac_f32_32x32x32_bf16 v[168:183], v[52:55], v[112:119], v200
    v_exp_f32 v124, v124
    v_exp_f32 v125, v125
    v_exp_f32 v126, v126
    v_exp_f32 v127, v127
    v_exp_f32 v128, v128
    v_exp_f32 v129, v129
    v_mfma_f32_32x32x16_bf16 v[88:103], v[32:35], v[20:23], v[152:167]
    s_mov_b32 m0, s32
    s_add_u32 s32, s32, 4096
    buffer_load_dwordx4 v1, s[8:11], s36 offen sc1 lds
    s_mov_b32 m0, s33
    s_add_u32 s33, s33, 4224
    buffer_load_dwordx4 v1, s[8:11], s37 offen sc1 lds
    s_add_u32 s36, s36, 4096
    s_add_u32 s37, s37, 4096
    v_exp_f32 v130, v130
    v_exp_f32 v131, v131
    v_exp_f32 v132, v132
    v_exp_f32 v133, v133
    v_smfmac_f32_32x32x32_bf16 v[184:199], v[48:51], v[120:127], v200
    v_exp_f32 v134, v134
    v_exp_f32 v135, v135
    v_exp_f32 v72, v72
    v_exp_f32 v73, v73
    v_exp_f32 v74, v74
    v_exp_f32 v75, v75
    v_smfmac_f32_32x32x32_bf16 v[184:199], v[52:55], v[128:135], v200
    s_waitcnt lgkmcnt(0)
    ds_read_b128 v[24:27], v201 offset:4096
    ds_read_b128 v[64:67], v202 offset:3168
    ds_read_b128 v[68:71], v203 offset:3680
    v_exp_f32 v76, v76
    v_exp_f32 v77, v77
    v_exp_f32 v78, v78
    v_exp_f32 v79, v79
    v_exp_f32 v80, v80
    v_exp_f32 v81, v81
    v_mfma_f32_32x32x16_bf16 v[104:119], v[36:39], v[16:19], v[136:151]
    s_mov_b32 m0, s32
    s_add_u32 s32, s32, 4096
    buffer_load_dwordx4 v1, s[8:11], s36 offen sc1 lds
    s_mov_b32 m0, s33
    s_add_u32 s33, s33, 4224
    buffer_load_dwordx4 v1, s[8:11], s37 offen sc1 lds
    s_add_u32 s36, s36, 4096
    s_add_u32 s37, s37, 4096
    v_exp_f32 v82, v82
    v_exp_f32 v83, v83
    v_exp_f32 v84, v84
    v_exp_f32 v85, v85
    v_smfmac_f32_32x32x32_bf16 v[168:183], v[56:59], v[72:79], v200
    v_exp_f32 v86, v86
    v_exp_f32 v87, v87
    v_exp_f32 v88, v88
    v_exp_f32 v89, v89
    v_exp_f32 v90, v90
    v_exp_f32 v91, v91
    v_smfmac_f32_32x32x32_bf16 v[168:183], v[60:63], v[80:87], v200
    v_exp_f32 v92, v92
    v_exp_f32 v93, v93
    v_exp_f32 v94, v94
    v_exp_f32 v95, v95
    v_exp_f32 v96, v96
    v_exp_f32 v97, v97
    v_mfma_f32_32x32x16_bf16 v[120:135], v[36:39], v[20:23], v[152:167]
    s_mov_b32 m0, s32
    s_add_u32 s32, s32, 4096
    buffer_load_dwordx4 v1, s[8:11], s36 offen sc1 lds
    s_mov_b32 m0, s33
    s_add_u32 s33, s33, 4224
    buffer_load_dwordx4 v1, s[8:11], s37 offen sc1 lds
    s_add_u32 s36, s36, 4096
    s_add_u32 s37, s37, 4096
    v_exp_f32 v98, v98
    v_exp_f32 v99, v99
    v_exp_f32 v100, v100
    v_exp_f32 v101, v101
    v_smfmac_f32_32x32x32_bf16 v[184:199], v[56:59], v[88:95], v200
    v_exp_f32 v102, v102
    v_exp_f32 v103, v103
    v_exp_f32 v104, v104
    v_exp_f32 v105, v105
    v_exp_f32 v106, v106
    v_exp_f32 v107, v107
    v_smfmac_f32_32x32x32_bf16 v[184:199], v[60:63], v[96:103], v200
    s_waitcnt lgkmcnt(0)
    ds_read_b128 v[28:31], v201 offset:5120
    ds_read_b128 v[40:43], v202 offset:4224
    ds_read_b128 v[44:47], v203 offset:4736
    v_exp_f32 v108, v108
    v_exp_f32 v109, v109
    v_exp_f32 v110, v110
    v_exp_f32 v111, v111
    v_exp_f32 v112, v112
    v_exp_f32 v113, v113
    v_mfma_f32_32x32x16_bf16 v[72:87], v[24:27], v[16:19], v[136:151]
    s_mov_b32 m0, s32
    s_add_u32 s32, s32, 4096
    buffer_load_dwordx4 v1, s[8:11], s36 offen sc1 lds
    s_mov_b32 m0, s33
    s_add_u32 s33, s33, 4224
    buffer_load_dwordx4 v1, s[8:11], s37 offen sc1 lds
    s_add_u32 s36, s36, 4096
    s_add_u32 s37, s37, 4096
    v_exp_f32 v114, v114
    v_exp_f32 v115, v115
    v_exp_f32 v116, v116
    v_exp_f32 v117, v117
    v_smfmac_f32_32x32x32_bf16 v[168:183], v[64:67], v[104:111], v200
    v_exp_f32 v118, v118
    v_exp_f32 v119, v119
    v_exp_f32 v120, v120
    v_exp_f32 v121, v121
    v_exp_f32 v122, v122
    v_exp_f32 v123, v123
    v_smfmac_f32_32x32x32_bf16 v[168:183], v[68:71], v[112:119], v200
    v_exp_f32 v124, v124
    v_exp_f32 v125, v125
    v_exp_f32 v126, v126
    v_exp_f32 v127, v127
    v_exp_f32 v128, v128
    v_exp_f32 v129, v129
    v_mfma_f32_32x32x16_bf16 v[88:103], v[24:27], v[20:23], v[152:167]
    s_mov_b32 m0, s32
    s_add_u32 s32, s32, 4096
    buffer_load_dwordx4 v1, s[8:11], s36 offen sc1 lds
    s_mov_b32 m0, s33
    s_add_u32 s33, s33, 4224
    buffer_load_dwordx4 v1, s[8:11], s37 offen sc1 lds
    s_add_u32 s36, s36, 4096
    s_add_u32 s37, s37, 4096
    v_exp_f32 v130, v130
    v_exp_f32 v131, v131
    v_exp_f32 v132, v132
    v_exp_f32 v133, v133
    v_smfmac_f32_32x32x32_bf16 v[184:199], v[64:67], v[120:127], v200
    v_exp_f32 v134, v134
    v_exp_f32 v135, v135
    v_exp_f32 v72, v72
    v_exp_f32 v73, v73
    v_exp_f32 v74, v74
    v_exp_f32 v75, v75
    v_smfmac_f32_32x32x32_bf16 v[184:199], v[68:71], v[128:135], v200
    s_waitcnt lgkmcnt(0)
    ds_read_b128 v[32:35], v201 offset:6144
    ds_read_b128 v[48:51], v202 offset:5280
    ds_read_b128 v[52:55], v203 offset:5792
    v_exp_f32 v76, v76
    v_exp_f32 v77, v77
    v_exp_f32 v78, v78
    v_exp_f32 v79, v79
    v_exp_f32 v80, v80
    v_exp_f32 v81, v81
    v_mfma_f32_32x32x16_bf16 v[104:119], v[28:31], v[16:19], v[136:151]
    s_mov_b32 m0, s32
    s_add_u32 s32, s32, 4096
    buffer_load_dwordx4 v1, s[8:11], s36 offen sc1 lds
    s_mov_b32 m0, s33
    s_add_u32 s33, s33, 4224
    buffer_load_dwordx4 v1, s[8:11], s37 offen sc1 lds
    s_add_u32 s36, s36, 4096
    s_add_u32 s37, s37, 4096
    v_exp_f32 v82, v82
    v_exp_f32 v83, v83
    v_exp_f32 v84, v84
    v_exp_f32 v85, v85
    v_smfmac_f32_32x32x32_bf16 v[168:183], v[40:43], v[72:79], v200
    v_exp_f32 v86, v86
    v_exp_f32 v87, v87
    v_exp_f32 v88, v88
    v_exp_f32 v89, v89
    v_exp_f32 v90, v90
    v_exp_f32 v91, v91
    v_smfmac_f32_32x32x32_bf16 v[168:183], v[44:47], v[80:87], v200
    v_exp_f32 v92, v92
    v_exp_f32 v93, v93
    v_exp_f32 v94, v94
    v_exp_f32 v95, v95
    v_exp_f32 v96, v96
    v_exp_f32 v97, v97
    v_mfma_f32_32x32x16_bf16 v[120:135], v[28:31], v[20:23], v[152:167]
    s_mov_b32 m0, s32
    s_add_u32 s32, s32, 4096
    buffer_load_dwordx4 v1, s[8:11], s36 offen sc1 lds
    s_mov_b32 m0, s33
    s_add_u32 s33, s33, 4224
    buffer_load_dwordx4 v1, s[8:11], s37 offen sc1 lds
    s_add_u32 s36, s36, 4096
    s_add_u32 s37, s37, 4096
    v_exp_f32 v98, v98
    v_exp_f32 v99, v99
    v_exp_f32 v100, v100
    v_exp_f32 v101, v101
    v_smfmac_f32_32x32x32_bf16 v[184:199], v[40:43], v[88:95], v200
    v_exp_f32 v102, v102
    v_exp_f32 v103, v103
    v_exp_f32 v104, v104
    v_exp_f32 v105, v105
    v_exp_f32 v106, v106
    v_exp_f32 v107, v107
    v_smfmac_f32_32x32x32_bf16 v[184:199], v[44:47], v[96:103], v200
    s_waitcnt lgkmcnt(0)
    ds_read_b128 v[36:39], v201 offset:7168
    ds_read_b128 v[56:59], v202 offset:6336
    ds_read_b128 v[60:63], v203 offset:6848
    v_exp_f32 v108, v108
    v_exp_f32 v109, v109
    v_exp_f32 v110, v110
    v_exp_f32 v111, v111
    v_exp_f32 v112, v112
    v_exp_f32 v113, v113
    v_mfma_f32_32x32x16_bf16 v[72:87], v[32:35], v[16:19], v[136:151]
    s_mov_b32 m0, s32
    s_add_u32 s32, s32, 4096
    buffer_load_dwordx4 v1, s[8:11], s36 offen sc1 lds
    s_mov_b32 m0, s33
    s_add_u32 s33, s33, 4224
    buffer_load_dwordx4 v1, s[8:11], s37 offen sc1 lds
    s_add_u32 s36, s36, 4096
    s_add_u32 s37, s37, 4096
    v_exp_f32 v114, v114
    v_exp_f32 v115, v115
    v_exp_f32 v116, v116
    v_exp_f32 v117, v117
    v_smfmac_f32_32x32x32_bf16 v[168:183], v[48:51], v[104:111], v200
    v_exp_f32 v118, v118
    v_exp_f32 v119, v119
    v_exp_f32 v120, v120
    v_exp_f32 v121, v121
    v_exp_f32 v122, v122
    v_exp_f32 v123, v123
    v_smfmac_f32_32x32x32_bf16 v[168:183], v[52:55], v[112:119], v200
    v_exp_f32 v124, v124
    v_exp_f32 v125, v125
    v_exp_f32 v126, v126
    v_exp_f32 v127, v127
    v_exp_f32 v128, v128
    v_exp_f32 v129, v129
    v_mfma_f32_32x32x16_bf16 v[88:103], v[32:35], v[20:23], v[152:167]
    s_mov_b32 m0, s32
    s_add_u32 s32, s32, 4096
    buffer_load_dwordx4 v1, s[8:11], s36 offen sc1 lds
    s_mov_b32 m0, s33
    s_add_u32 s33, s33, 4224
    buffer_load_dwordx4 v1, s[8:11], s37 offen sc1 lds
    s_add_u32 s36, s36, 4096
    s_add_u32 s37, s37, 4096
    v_exp_f32 v130, v130
    v_exp_f32 v131, v131
    v_exp_f32 v132, v132
    v_exp_f32 v133, v133
    v_smfmac_f32_32x32x32_bf16 v[184:199], v[48:51], v[120:127], v200
    v_exp_f32 v134, v134
    v_exp_f32 v135, v135
    v_exp_f32 v72, v72
    v_exp_f32 v73, v73
    v_exp_f32 v74, v74
    v_exp_f32 v75, v75
    v_smfmac_f32_32x32x32_bf16 v[184:199], v[52:55], v[128:135], v200
    s_waitcnt lgkmcnt(0)
    ds_read_b128 v[24:27], v201 offset:8192
    ds_read_b128 v[64:67], v202 offset:7392
    ds_read_b128 v[68:71], v203 offset:7904
    v_exp_f32 v76, v76
    v_exp_f32 v77, v77
    v_exp_f32 v78, v78
    v_exp_f32 v79, v79
    v_exp_f32 v80, v80
    v_exp_f32 v81, v81
    v_mfma_f32_32x32x16_bf16 v[104:119], v[36:39], v[16:19], v[136:151]
    s_mov_b32 m0, s32
    s_add_u32 s32, s32, 4096
    buffer_load_dwordx4 v1, s[8:11], s36 offen sc1 lds
    s_mov_b32 m0, s33
    s_add_u32 s33, s33, 4224
    buffer_load_dwordx4 v1, s[8:11], s37 offen sc1 lds
    s_add_u32 s36, s36, 4096
    s_add_u32 s37, s37, 4096
    v_exp_f32 v82, v82
    v_exp_f32 v83, v83
    v_exp_f32 v84, v84
    v_exp_f32 v85, v85
    v_smfmac_f32_32x32x32_bf16 v[168:183], v[56:59], v[72:79], v200
    v_exp_f32 v86, v86
    v_exp_f32 v87, v87
    v_exp_f32 v88, v88
    v_exp_f32 v89, v89
    v_exp_f32 v90, v90
    v_exp_f32 v91, v91
    v_smfmac_f32_32x32x32_bf16 v[168:183], v[60:63], v[80:87], v200
    v_exp_f32 v92, v92
    v_exp_f32 v93, v93
    v_exp_f32 v94, v94
    v_exp_f32 v95, v95
    v_exp_f32 v96, v96
    v_exp_f32 v97, v97
    v_mfma_f32_32x32x16_bf16 v[120:135], v[36:39], v[20:23], v[152:167]
    v_exp_f32 v98, v98
    v_exp_f32 v99, v99
    v_exp_f32 v100, v100
    v_exp_f32 v101, v101
    v_smfmac_f32_32x32x32_bf16 v[184:199], v[56:59], v[88:95], v200
    v_exp_f32 v102, v102
    v_exp_f32 v103, v103
    v_exp_f32 v104, v104
    v_exp_f32 v105, v105
    v_exp_f32 v106, v106
    v_exp_f32 v107, v107
    v_smfmac_f32_32x32x32_bf16 v[184:199], v[60:63], v[96:103], v200
    s_waitcnt lgkmcnt(0)
    ds_read_b128 v[28:31], v201 offset:9216
    ds_read_b128 v[40:43], v202 offset:8448
    ds_read_b128 v[44:47], v203 offset:8960
    v_exp_f32 v108, v108
    v_exp_f32 v109, v109
    v_exp_f32 v110, v110
    v_exp_f32 v111, v111
    v_exp_f32 v112, v112
    v_exp_f32 v113, v113
    v_mfma_f32_32x32x16_bf16 v[72:87], v[24:27], v[16:19], v[136:151]
    v_exp_f32 v114, v114
    v_exp_f32 v115, v115
    v_exp_f32 v116, v116
    v_exp_f32 v117, v117
    v_smfmac_f32_32x32x32_bf16 v[168:183], v[64:67], v[104:111], v200
    v_exp_f32 v118, v118
    v_exp_f32 v119, v119
    v_exp_f32 v120, v120
    v_exp_f32 v121, v121
    v_exp_f32 v122, v122
    v_exp_f32 v123, v123
    v_smfmac_f32_32x32x32_bf16 v[168:183], v[68:71], v[112:119], v200
    v_exp_f32 v124, v124
    v_exp_f32 v125, v125
    v_exp_f32 v126, v126
    v_exp_f32 v127, v127
    v_exp_f32 v128, v128
    v_exp_f32 v129, v129
    v_mfma_f32_32x32x16_bf16 v[88:103], v[24:27], v[20:23], v[152:167]
    v_exp_f32 v130, v130
    v_exp_f32 v131, v131
    v_exp_f32 v132, v132
    v_exp_f32 v133, v133
    v_smfmac_f32_32x32x32_bf16 v[184:199], v[64:67], v[120:127], v200
    v_exp_f32 v134, v134
    v_exp_f32 v135, v135
    v_add_u32 v201, 0x2000, v201
    v_add_u32 v202, 8448, v202
    v_add_u32 v203, 8448, v203
    s_waitcnt vmcnt(0)
    s_barrier
    s_mov_b32 s38, 7
LA_loop:
    v_exp_f32 v72, v72
    v_exp_f32 v73, v73
    v_exp_f32 v74, v74
    v_exp_f32 v75, v75
    v_smfmac_f32_32x32x32_bf16 v[184:199], v[68:71], v[128:135], v200
    s_waitcnt lgkmcnt(0)
    ds_read_b128 v[32:35], v201 offset:2048
    ds_read_b128 v[48:51], v202 offset:1056
    ds_read_b128 v[52:55], v203 offset:1568
    v_exp_f32 v76, v76
    v_exp_f32 v77, v77
    v_exp_f32 v78, v78
    v_exp_f32 v79, v79
    v_exp_f32 v80, v80
    v_exp_f32 v81, v81
    v_mfma_f32_32x32x16_bf16 v[104:119], v[28:31], v[16:19], v[136:151]
    v_exp_f32 v82, v82
    v_exp_f32 v83, v83
    v_exp_f32 v84, v84
    v_exp_f32 v85, v85
    v_smfmac_f32_32x32x32_bf16 v[168:183], v[40:43], v[72:79], v200
    v_exp_f32 v86, v86
    v_exp_f32 v87, v87
    v_exp_f32 v88, v88
    v_exp_f32 v89, v89
    v_exp_f32 v90, v90
    v_exp_f32 v91, v91
    v_smfmac_f32_32x32x32_bf16 v[168:183], v[44:47], v[80:87], v200
    v_exp_f32 v92, v92
    v_exp_f32 v93, v93
    v_exp_f32 v94, v94
    v_exp_f32 v95, v95
    v_exp_f32 v96, v96
    v_exp_f32 v97, v97
    v_mfma_f32_32x32x16_bf16 v[120:135], v[28:31], v[20:23], v[152:167]
    v_exp_f32 v98, v98
    v_exp_f32 v99, v99
    v_exp_f32 v100, v100
    v_exp_f32 v101, v101
    v_smfmac_f32_32x32x32_bf16 v[184:199], v[40:43], v[88:95], v200
    v_exp_f32 v102, v102
    v_exp_f32 v103, v103
    v_exp_f32 v104, v104
    v_exp_f32 v105, v105
    v_exp_f32 v106, v106
    v_exp_f32 v107, v107
    v_smfmac_f32_32x32x32_bf16 v[184:199], v[44:47], v[96:103], v200
    s_waitcnt lgkmcnt(0)
    ds_read_b128 v[36:39], v201 offset:3072
    ds_read_b128 v[56:59], v202 offset:2112
    ds_read_b128 v[60:63], v203 offset:2624
    v_exp_f32 v108, v108
    v_exp_f32 v109, v109
    v_exp_f32 v110, v110
    v_exp_f32 v111, v111
    v_exp_f32 v112, v112
    v_exp_f32 v113, v113
    v_mfma_f32_32x32x16_bf16 v[72:87], v[32:35], v[16:19], v[136:151]
    v_exp_f32 v114, v114
    v_exp_f32 v115, v115
    v_exp_f32 v116, v116
    v_exp_f32 v117, v117
    v_smfmac_f32_32x32x32_bf16 v[168:183], v[48:51], v[104:111], v200
    v_exp_f32 v118, v118
    v_exp_f32 v119, v119
    v_exp_f32 v120, v120
    v_exp_f32 v121, v121
    v_exp_f32 v122, v122
    v_exp_f32 v123, v123
    v_smfmac_f32_32x32x32_bf16 v[168:183], v[52:55], v[112:119], v200
    v_exp_f32 v124, v124
    v_exp_f32 v125, v125
    v_exp_f32 v126, v126
    v_exp_f32 v127, v127
    v_exp_f32 v128, v128
    v_exp_f32 v129, v129
    v_mfma_f32_32x32x16_bf16 v[88:103], v[32:35], v[20:23], v[152:167]
    v_exp_f32 v130, v130
    v_exp_f32 v131, v131
    v_exp_f32 v132, v132
    v_exp_f32 v133, v133
    v_smfmac_f32_32x32x32_bf16 v[184:199], v[48:51], v[120:127], v200
    v_exp_f32 v134, v134
    v_exp_f32 v135, v135
    v_exp_f32 v72, v72
    v_exp_f32 v73, v73
    v_exp_f32 v74, v74
    v_exp_f32 v75, v75
    v_smfmac_f32_32x32x32_bf16 v[184:199], v[52:55], v[128:135], v200
    s_waitcnt lgkmcnt(0)
    ds_read_b128 v[24:27], v201 offset:4096
    ds_read_b128 v[64:67], v202 offset:3168
    ds_read_b128 v[68:71], v203 offset:3680
    v_exp_f32 v76, v76
    v_exp_f32 v77, v77
    v_exp_f32 v78, v78
    v_exp_f32 v79, v79
    v_exp_f32 v80, v80
    v_exp_f32 v81, v81
    v_mfma_f32_32x32x16_bf16 v[104:119], v[36:39], v[16:19], v[136:151]
    v_exp_f32 v82, v82
    v_exp_f32 v83, v83
    v_exp_f32 v84, v84
    v_exp_f32 v85, v85
    v_smfmac_f32_32x32x32_bf16 v[168:183], v[56:59], v[72:79], v200
    v_exp_f32 v86, v86
    v_exp_f32 v87, v87
    v_exp_f32 v88, v88
    v_exp_f32 v89, v89
    v_exp_f32 v90, v90
    v_exp_f32 v91, v91
    v_smfmac_f32_32x32x32_bf16 v[168:183], v[60:63], v[80:87], v200
    v_exp_f32 v92, v92
    v_exp_f32 v93, v93
    v_exp_f32 v94, v94
    v_exp_f32 v95, v95
    v_exp_f32 v96, v96
    v_exp_f32 v97, v97
    v_mfma_f32_32x32x16_bf16 v[120:135], v[36:39], v[20:23], v[152:167]
    v_exp_f32 v98, v98
    v_exp_f32 v99, v99
    v_exp_f32 v100, v100
    v_exp_f32 v101, v101
    v_smfmac_f32_32x32x32_bf16 v[184:199], v[56:59], v[88:95], v200
    v_exp_f32 v102, v102
    v_exp_f32 v103, v103
    v_exp_f32 v104, v104
    v_exp_f32 v105, v105
    v_exp_f32 v106, v106
    v_exp_f32 v107, v107
    v_smfmac_f32_32x32x32_bf16 v[184:199], v[60:63], v[96:103], v200
    s_waitcnt lgkmcnt(0)
    ds_read_b128 v[28:31], v201 offset:5120
    ds_read_b128 v[40:43], v202 offset:4224
    ds_read_b128 v[44:47], v203 offset:4736
    v_exp_f32 v108, v108
    v_exp_f32 v109, v109
    v_exp_f32 v110, v110
    v_exp_f32 v111, v111
    v_exp_f32 v112, v112
    v_exp_f32 v113, v113
    v_mfma_f32_32x32x16_bf16 v[72:87], v[24:27], v[16:19], v[136:151]
    v_exp_f32 v114, v114
    v_exp_f32 v115, v115
    v_exp_f32 v116, v116
    v_exp_f32 v117, v117
    v_smfmac_f32_32x32x32_bf16 v[168:183], v[64:67], v[104:111], v200
    v_exp_f32 v118, v118
    v_exp_f32 v119, v119
    v_exp_f32 v120, v120
    v_exp_f32 v121, v121
    v_exp_f32 v122, v122
    v_exp_f32 v123, v123
    v_smfmac_f32_32x32x32_bf16 v[168:183], v[68:71], v[112:119], v200
    v_exp_f32 v124, v124
    v_exp_f32 v125, v125
    v_exp_f32 v126, v126
    v_exp_f32 v127, v127
    v_exp_f32 v128, v128
    v_exp_f32 v129, v129
    v_mfma_f32_32x32x16_bf16 v[88:103], v[24:27], v[20:23], v[152:167]
    v_exp_f32 v130, v130
    v_exp_f32 v131, v131
    v_exp_f32 v132, v132
    v_exp_f32 v133, v133
    v_smfmac_f32_32x32x32_bf16 v[184:199], v[64:67], v[120:127], v200
    v_exp_f32 v134, v134
    v_exp_f32 v135, v135
    v_exp_f32 v72, v72
    v_exp_f32 v73, v73
    v_exp_f32 v74, v74
    v_exp_f32 v75, v75
    v_smfmac_f32_32x32x32_bf16 v[184:199], v[68:71], v[128:135], v200
    s_waitcnt lgkmcnt(0)
    ds_read_b128 v[32:35], v201 offset:6144
    ds_read_b128 v[48:51], v202 offset:5280
    ds_read_b128 v[52:55], v203 offset:5792
    v_exp_f32 v76, v76
    v_exp_f32 v77, v77
    v_exp_f32 v78, v78
    v_exp_f32 v79, v79
    v_exp_f32 v80, v80
    v_exp_f32 v81, v81
    v_mfma_f32_32x32x16_bf16 v[104:119], v[28:31], v[16:19], v[136:151]
    v_exp_f32 v82, v82
    v_exp_f32 v83, v83
    v_exp_f32 v84, v84
    v_exp_f32 v85, v85
    v_smfmac_f32_32x32x32_bf16 v[168:183], v[40:43], v[72:79], v200
    v_exp_f32 v86, v86
    v_exp_f32 v87, v87
    v_exp_f32 v88, v88
    v_exp_f32 v89, v89
    v_exp_f32 v90, v90
    v_exp_f32 v91, v91
    v_smfmac_f32_32x32x32_bf16 v[168:183], v[44:47], v[80:87], v200
    v_exp_f32 v92, v92
    v_exp_f32 v93, v93
    v_exp_f32 v94, v94
    v_exp_f32 v95, v95
    v_exp_f32 v96, v96
    v_exp_f32 v97, v97
    v_mfma_f32_32x32x16_bf16 v[120:135], v[28:31], v[20:23], v[152:167]
    v_exp_f32 v98, v98
    v_exp_f32 v99, v99
    v_exp_f32 v100, v100
    v_exp_f32 v101, v101
    v_smfmac_f32_32x32x32_bf16 v[184:199], v[40:43], v[88:95], v200
    v_exp_f32 v102, v102
    v_exp_f32 v103, v103
    v_exp_f32 v104, v104
    v_exp_f32 v105, v105
    v_exp_f32 v106, v106
    v_exp_f32 v107, v107
    v_smfmac_f32_32x32x32_bf16 v[184:199], v[44:47], v[96:103], v200
    s_waitcnt lgkmcnt(0)
    ds_read_b128 v[36:39], v201 offset:7168
    ds_read_b128 v[56:59], v202 offset:6336
    ds_read_b128 v[60:63], v203 offset:6848
    v_exp_f32 v108, v108
    v_exp_f32 v109, v109
    v_exp_f32 v110, v110
    v_exp_f32 v111, v111
    v_exp_f32 v112, v112
    v_exp_f32 v113, v113
    v_mfma_f32_32x32x16_bf16 v[72:87], v[32:35], v[16:19], v[136:151]
    v_exp_f32 v114, v114
    v_exp_f32 v115, v115
    v_exp_f32 v116, v116
    v_exp_f32 v117, v117
    v_smfmac_f32_32x32x32_bf16 v[168:183], v[48:51], v[104:111], v200
    v_exp_f32 v118, v118
    v_exp_f32 v119, v119
    v_exp_f32 v120, v120
    v_exp_f32 v121, v121
    v_exp_f32 v122, v122
    v_exp_f32 v123, v123
    v_smfmac_f32_32x32x32_bf16 v[168:183], v[52:55], v[112:119], v200
    v_exp_f32 v124, v124
    v_exp_f32 v125, v125
    v_exp_f32 v126, v126
    v_exp_f32 v127, v127
    v_exp_f32 v128, v128
    v_exp_f32 v129, v129
    v_mfma_f32_32x32x16_bf16 v[88:103], v[32:35], v[20:23], v[152:167]
    v_exp_f32 v130, v130
    v_exp_f32 v131, v131
    v_exp_f32 v132, v132
    v_exp_f32 v133, v133
    v_smfmac_f32_32x32x32_bf16 v[184:199], v[48:51], v[120:127], v200
    v_exp_f32 v134, v134
    v_exp_f32 v135, v135
    v_exp_f32 v72, v72
    v_exp_f32 v73, v73
    v_exp_f32 v74, v74
    v_exp_f32 v75, v75
    v_smfmac_f32_32x32x32_bf16 v[184:199], v[52:55], v[128:135], v200
    s_waitcnt lgkmcnt(0)
    ds_read_b128 v[24:27], v201 offset:8192
    ds_read_b128 v[64:67], v202 offset:7392
    ds_read_b128 v[68:71], v203 offset:7904
    v_exp_f32 v76, v76
    v_exp_f32 v77, v77
    v_exp_f32 v78, v78
    v_exp_f32 v79, v79
    v_exp_f32 v80, v80
    v_exp_f32 v81, v81
    v_mfma_f32_32x32x16_bf16 v[104:119], v[36:39], v[16:19], v[136:151]
    v_exp_f32 v82, v82
    v_exp_f32 v83, v83
    v_exp_f32 v84, v84
    v_exp_f32 v85, v85
    v_smfmac_f32_32x32x32_bf16 v[168:183], v[56:59], v[72:79], v200
    v_exp_f32 v86, v86
    v_exp_f32 v87, v87
    v_exp_f32 v88, v88
    v_exp_f32 v89, v89
    v_exp_f32 v90, v90
    v_exp_f32 v91, v91
    v_smfmac_f32_32x32x32_bf16 v[168:183], v[60:63], v[80:87], v200
    v_exp_f32 v92, v92
    v_exp_f32 v93, v93
    v_exp_f32 v94, v94
    v_exp_f32 v95, v95
    v_exp_f32 v96, v96
    v_exp_f32 v97, v97
    v_mfma_f32_32x32x16_bf16 v[120:135], v[36:39], v[20:23], v[152:167]
    v_exp_f32 v98, v98
    v_exp_f32 v99, v99
    v_exp_f32 v100, v100
    v_exp_f32 v101, v101
    v_smfmac_f32_32x32x32_bf16 v[184:199], v[56:59], v[88:95], v200
    v_exp_f32 v102, v102
    v_exp_f32 v103, v103
    v_exp_f32 v104, v104
    v_exp_f32 v105, v105
    v_exp_f32 v106, v106
    v_exp_f32 v107, v107
    v_smfmac_f32_32x32x32_bf16 v[184:199], v[60:63], v[96:103], v200
    s_waitcnt lgkmcnt(0)
    ds_read_b128 v[28:31], v201 offset:9216
    ds_read_b128 v[40:43], v202 offset:8448
    ds_read_b128 v[44:47], v203 offset:8960
    v_exp_f32 v108, v108
    v_exp_f32 v109, v109
    v_exp_f32 v110, v110
    v_exp_f32 v111, v111
    v_exp_f32 v112, v112
    v_exp_f32 v113, v113
    v_mfma_f32_32x32x16_bf16 v[72:87], v[24:27], v[16:19], v[136:151]
    v_exp_f32 v114, v114
    v_exp_f32 v115, v115
    v_exp_f32 v116, v116
    v_exp_f32 v117, v117
    v_smfmac_f32_32x32x32_bf16 v[168:183], v[64:67], v[104:111], v200
    v_exp_f32 v118, v118
    v_exp_f32 v119, v119
    v_exp_f32 v120, v120
    v_exp_f32 v121, v121
    v_exp_f32 v122, v122
    v_exp_f32 v123, v123
    v_smfmac_f32_32x32x32_bf16 v[168:183], v[68:71], v[112:119], v200
    v_exp_f32 v124, v124
    v_exp_f32 v125, v125
    v_exp_f32 v126, v126
    v_exp_f32 v127, v127
    v_exp_f32 v128, v128
    v_exp_f32 v129, v129
    v_mfma_f32_32x32x16_bf16 v[88:103], v[24:27], v[20:23], v[152:167]
    v_exp_f32 v130, v130
    v_exp_f32 v131, v131
    v_exp_f32 v132, v132
    v_exp_f32 v133, v133
    v_smfmac_f32_32x32x32_bf16 v[184:199], v[64:67], v[120:127], v200
    v_exp_f32 v134, v134
    v_exp_f32 v135, v135
    v_add_u32 v201, 0x2000, v201
    v_add_u32 v202, 8448, v202
    v_add_u32 v203, 8448, v203
    s_sub_u32 s38, s38, 1
    s_cmp_lg_u32 s38, 0
    s_cbranch_scc1 LA_loop
    v_smfmac_f32_32x32x32_bf16 v[184:199], v[68:71], v[128:135], v200
    v_and_b32 v24, 31, v2
    v_lshrrev_b32 v25, 4, v24
    v_lshlrev_b32 v25, 10, v25
    v_lshrrev_b32 v26, 5, v2
    v_lshl_add_u32 v25, v26, 8, v25
    v_lshl_add_u32 v25, v3, 4, v25
    s_lshl_b32 s30, s19, 2
    s_add_u32 s30, s30, s3
    s_lshl_b32 s30, s30, 4
    s_lshr_b32 s31, s18, 1
    s_add_u32 s30, s30, s31
    s_lshl_b32 s30, s30, 12
    s_and_b32 s31, s18, 1
    s_lshl_b32 s31, s31, 9
    s_add_u32 s30, s30, s31
    s_add_u32 s30, s30, s24
    s_add_u32 s30, s30, 0x1200000
    s_waitcnt lgkmcnt(0)
    s_cmp_lg_u32 s39, 0
    s_cbranch_scc1 LA_fin
    v_mov_b32 v208, 0x4e800000
    v_max_f32 v209, v176, v192
    v_add_f32 v210, v176, v192
    v_cmp_nlt_f32 vcc, v209, v208
    v_cmp_u_f32 s[40:41], v210, v210
    s_nop 3
    s_or_b64 vcc, vcc, s[40:41]
    s_cbranch_vccz LA_fin
    s_mov_b32 s39, 1
    v_mov_b32 v206, 0xff800000
    v_mov_b32 v207, 0xff800000
    v_mov_b32 v201, v1
    s_mov_b32 s38, 64
LA_maxloop:
    ds_read_b128 v[24:27], v201
    s_waitcnt lgkmcnt(0)
    v_mfma_f32_32x32x16_bf16 v[72:87], v[24:27], v[16:19], 0
    v_mfma_f32_32x32x16_bf16 v[88:103], v[24:27], v[20:23], 0
    s_nop 15
    s_nop 3
    v_max3_f32 v206, v206, v72, v73
    v_max3_f32 v206, v206, v74, v75
    v_max3_f32 v206, v206, v76, v77
    v_max3_f32 v206, v206, v78, v79
    v_max3_f32 v206, v206, v80, v81
    v_max3_f32 v206, v206, v82, v83
    v_max3_f32 v206, v206, v84, v85
    v_max3_f32 v206, v206, v86, v87
    v_max3_f32 v207, v207, v88, v89
    v_max3_f32 v207, v207, v90, v91
    v_max3_f32 v207, v207, v92, v93
    v_max3_f32 v207, v207, v94, v95
    v_max3_f32 v207, v207, v96, v97
    v_max3_f32 v207, v207, v98, v99
    v_max3_f32 v207, v207, v100, v101
    v_max3_f32 v207, v207, v102, v103
    v_add_u32 v201, 0x400, v201
    s_sub_u32 s38, s38, 1
    s_cmp_lg_u32 s38, 0
    s_cbranch_scc1 LA_maxloop
    v_mov_b32 v168, 0
    v_mov_b32 v184, 0
    v_mov_b32 v120, 0
    v_mov_b32 v169, 0
    v_mov_b32 v185, 0
    v_mov_b32 v121, 0
    v_mov_b32 v170, 0
    v_mov_b32 v186, 0
    v_mov_b32 v122, 0
    v_mov_b32 v171, 0
    v_mov_b32 v187, 0
    v_mov_b32 v123, 0
    v_mov_b32 v172, 0
    v_mov_b32 v188, 0
    v_mov_b32 v124, 0
    v_mov_b32 v173, 0
    v_mov_b32 v189, 0
    v_mov_b32 v125, 0
    v_mov_b32 v174, 0
    v_mov_b32 v190, 0
    v_mov_b32 v126, 0
    v_mov_b32 v175, 0
    v_mov_b32 v191, 0
    v_mov_b32 v127, 0
    v_mov_b32 v176, 0
    v_mov_b32 v192, 0
    v_mov_b32 v128, 0
    v_mov_b32 v177, 0
    v_mov_b32 v193, 0
    v_mov_b32 v129, 0
    v_mov_b32 v178, 0
    v_mov_b32 v194, 0
    v_mov_b32 v130, 0
    v_mov_b32 v179, 0
    v_mov_b32 v195, 0
    v_mov_b32 v131, 0
    v_mov_b32 v180, 0
    v_mov_b32 v196, 0
    v_mov_b32 v132, 0
    v_mov_b32 v181, 0
    v_mov_b32 v197, 0
    v_mov_b32 v133, 0
    v_mov_b32 v182, 0
    v_mov_b32 v198, 0
    v_mov_b32 v134, 0
    v_mov_b32 v183, 0
    v_mov_b32 v199, 0
    v_mov_b32 v135, 0
    s_branch LA_restart
LA_fin:
    v_rcp_f32 v206, v176
    v_rcp_f32 v207, v192
    s_nop 0
    v_mul_f32 v168, v206, v168
    v_mul_f32 v169, v206, v169
    v_mul_f32 v170, v206, v170
    v_mul_f32 v171, v206, v171
    v_mul_f32 v172, v206, v172
    v_mul_f32 v173, v206, v173
    v_mul_f32 v174, v206, v174
    v_mul_f32 v175, v206, v175
    v_cvt_pk_bf16_f32 v28, v168, v169
    v_cvt_pk_bf16_f32 v29, v170, v171
    v_cvt_pk_bf16_f32 v30, v172, v173
    v_cvt_pk_bf16_f32 v31, v174, v175
    buffer_store_dwordx4 v[28:31], v25, s[8:11], s30 offen offset:0 sc1
    v_mul_f32 v184, v207, v184
    v_mul_f32 v185, v207, v185
    v_mul_f32 v186, v207, v186
    v_mul_f32 v187, v207, v187
    v_mul_f32 v188, v207, v188
    v_mul_f32 v189, v207, v189
    v_mul_f32 v190, v207, v190
    v_mul_f32 v191, v207, v191
    v_cvt_pk_bf16_f32 v32, v184, v185
    v_cvt_pk_bf16_f32 v33, v186, v187
    v_cvt_pk_bf16_f32 v34, v188, v189
    v_cvt_pk_bf16_f32 v35, v190, v191
    buffer_store_dwordx4 v[32:35], v25, s[8:11], s30 offen offset:2048 sc1
    s_lshl_b32 s40, s19, 8
    s_lshl_b32 s41, s18, 2
    s_add_u32 s40, s40, s41
    s_add_u32 s40, s40, s26
    s_add_u32 s40, s40, 4096
    v_mov_b32 v6, 1
    v_mov_b32 v7, 0
    s_waitcnt vmcnt(0)
    s_barrier
    s_cmp_lg_u32 s3, 0
    s_cbranch_scc1 LSG_3
    s_mov_b64 exec, 1
    buffer_store_dword v6, v7, s[8:11], s40 offen sc1
    s_mov_b64 exec, -1
LSG_3:
    s_add_u32 s52, s51, 65536
    s_mov_b32 m0, s52
    s_add_u32 s53, s50, 4096
    buffer_load_dwordx4 v1, s[8:11], s50 offen offset:0 lds
    buffer_load_dwordx4 v1, s[8:11], s50 offen offset:1024 lds
    buffer_load_dwordx4 v1, s[8:11], s50 offen offset:2048 lds
    buffer_load_dwordx4 v1, s[8:11], s50 offen offset:3072 lds
    s_add_u32 s52, s51, 69632
    s_mov_b32 m0, s52
    s_add_u32 s50, s50, 32768
    buffer_load_dwordx4 v1, s[8:11], s53 offen offset:0 lds
    buffer_load_dwordx4 v1, s[8:11], s53 offen offset:1024 lds
    buffer_load_dwordx4 v1, s[8:11], s53 offen offset:2048 lds
    buffer_load_dwordx4 v1, s[8:11], s53 offen offset:3072 lds
    s_add_u32 s52, s51, 98304
    s_mov_b32 m0, s52
    s_add_u32 s53, s50, 4096
    buffer_load_dwordx4 v1, s[8:11], s50 offen offset:0 lds
    buffer_load_dwordx4 v1, s[8:11], s50 offen offset:1024 lds
    buffer_load_dwordx4 v1, s[8:11], s50 offen offset:2048 lds
    buffer_load_dwordx4 v1, s[8:11], s50 offen offset:3072 lds
    s_add_u32 s52, s51, 102400
    s_mov_b32 m0, s52
    s_add_u32 s50, s50, 32768
    buffer_load_dwordx4 v1, s[8:11], s53 offen offset:0 lds
    buffer_load_dwordx4 v1, s[8:11], s53 offen offset:1024 lds
    buffer_load_dwordx4 v1, s[8:11], s53 offen offset:2048 lds
    buffer_load_dwordx4 v1, s[8:11], s53 offen offset:3072 lds
    s_add_u32 s52, s51, 131072
    s_mov_b32 m0, s52
    s_add_u32 s53, s50, 4096
    buffer_load_dwordx4 v1, s[8:11], s50 offen offset:0 lds
    buffer_load_dwordx4 v1, s[8:11], s50 offen offset:1024 lds
    buffer_load_dwordx4 v1, s[8:11], s50 offen offset:2048 lds
    buffer_load_dwordx4 v1, s[8:11], s50 offen offset:3072 lds
    s_add_u32 s52, s51, 135168
    s_mov_b32 m0, s52
    s_add_u32 s50, s50, 32768
    buffer_load_dwordx4 v1, s[8:11], s53 offen offset:0 lds
    buffer_load_dwordx4 v1, s[8:11], s53 offen offset:1024 lds
    buffer_load_dwordx4 v1, s[8:11], s53 offen offset:2048 lds
    buffer_load_dwordx4 v1, s[8:11], s53 offen offset:3072 lds
    s_lshr_b32 s35, s20, 2
    s_lshl_b32 s30, s20, 4
    s_lshl_b32 s31, s3, 2
    s_add_u32 s30, s30, s31
    s_lshl_b32 s30, s30, 12
    s_add_u32 s30, s30, s24
    s_add_u32 s30, s30, 0x1200000
    s_cmp_lg_u32 s3, 0
    s_cbranch_scc1 LPO_4
    s_lshl_b32 s40, s35, 8
    s_add_u32 s40, s40, s26
    s_add_u32 s40, s40, 4096
    s_mov_b32 s42, 0xffffffff
    s_mov_b32 s43, 0
    s_mov_b64 exec, s[42:43]
    s_mov_b32 s41, 0
LPL_4:
    buffer_load_dword v6, v5, s[8:11], s40 offen sc1
    s_add_u32 s41, s41, 1
    s_waitcnt vmcnt(0)
    v_cmp_ne_u32 vcc, 1, v6
    s_cmp_gt_u32 s41, 100000
    s_cbranch_scc1 LPX_4
    s_nop 2
    s_cbranch_vccnz LPL_4
LPX_4:
    s_mov_b64 exec, -1
LPO_4:
    s_barrier
    buffer_load_dwordx4 v[16:19], v10, s[8:11], s30 offen sc1
    buffer_load_dwordx4 v[20:23], v11, s[8:11], s30 offen sc1
    buffer_load_dwordx4 v[24:27], v12, s[8:11], s30 offen sc1
    buffer_load_dwordx4 v[28:31], v13, s[8:11], s30 offen sc1
    s_add_u32 s30, s30, 4096
    buffer_load_dwordx4 v[32:35], v10, s[8:11], s30 offen sc1
    buffer_load_dwordx4 v[36:39], v11, s[8:11], s30 offen sc1
    buffer_load_dwordx4 v[40:43], v12, s[8:11], s30 offen sc1
    buffer_load_dwordx4 v[44:47], v13, s[8:11], s30 offen sc1
    s_add_u32 s30, s30, 4096
    buffer_load_dwordx4 v[48:51], v10, s[8:11], s30 offen sc1
    buffer_load_dwordx4 v[52:55], v11, s[8:11], s30 offen sc1
    buffer_load_dwordx4 v[56:59], v12, s[8:11], s30 offen sc1
    buffer_load_dwordx4 v[60:63], v13, s[8:11], s30 offen sc1
    s_add_u32 s30, s30, 4096
    buffer_load_dwordx4 v[64:67], v10, s[8:11], s30 offen sc1
    buffer_load_dwordx4 v[68:71], v11, s[8:11], s30 offen sc1
    buffer_load_dwordx4 v[72:75], v12, s[8:11], s30 offen sc1
    buffer_load_dwordx4 v[76:79], v13, s[8:11], s30 offen sc1
    s_add_u32 s30, s30, 4096
    s_xor_b32 s34, s3, 1
    s_mul_i32 s34, s34, 12288
    s_add_u32 s34, s34, 0
    v_add_u32 v208, s34, v1
    s_xor_b32 s34, s3, 2
    s_mul_i32 s34, s34, 12288
    s_add_u32 s34, s34, 4096
    v_add_u32 v209, s34, v1
    s_xor_b32 s34, s3, 3
    s_mul_i32 s34, s34, 12288
    s_add_u32 s34, s34, 8192
    v_add_u32 v210, s34, v1
    s_mul_i32 s34, s3, 12288
    s_add_u32 s34, s34, 0
    v_add_u32 v211, s34, v1
    s_waitcnt vmcnt(12)
    v_mfma_f32_16x16x32_bf16 v[96:99], a[0:3], v[20:23], 0
    v_mfma_f32_16x16x32_bf16 v[100:103], a[4:7], v[20:23], 0
    v_mfma_f32_16x16x32_bf16 v[104:107], a[8:11], v[20:23], 0
    v_mfma_f32_16x16x32_bf16 v[108:111], a[12:15], v[20:23], 0
    v_mfma_f32_16x16x32_bf16 v[112:115], a[0:3], v[24:27], 0
    v_mfma_f32_16x16x32_bf16 v[116:119], a[4:7], v[24:27], 0
    v_mfma_f32_16x16x32_bf16 v[120:123], a[8:11], v[24:27], 0
    v_mfma_f32_16x16x32_bf16 v[124:127], a[12:15], v[24:27], 0
    v_mfma_f32_16x16x32_bf16 v[128:131], a[0:3], v[28:31], 0
    v_mfma_f32_16x16x32_bf16 v[132:135], a[4:7], v[28:31], 0
    v_mfma_f32_16x16x32_bf16 v[136:139], a[8:11], v[28:31], 0
    v_mfma_f32_16x16x32_bf16 v[140:143], a[12:15], v[28:31], 0
    v_mfma_f32_16x16x32_bf16 v[80:83], a[0:3], v[16:19], 0
    v_mfma_f32_16x16x32_bf16 v[84:87], a[4:7], v[16:19], 0
    v_mfma_f32_16x16x32_bf16 v[88:91], a[8:11], v[16:19], 0
    v_mfma_f32_16x16x32_bf16 v[92:95], a[12:15], v[16:19], 0
    s_waitcnt vmcnt(8)
    v_mfma_f32_16x16x32_bf16 v[96:99], a[16:19], v[36:39], v[96:99]
    v_mfma_f32_16x16x32_bf16 v[100:103], a[20:23], v[36:39], v[100:103]
    v_mfma_f32_16x16x32_bf16 v[104:107], a[24:27], v[36:39], v[104:107]
    v_mfma_f32_16x16x32_bf16 v[108:111], a[28:31], v[36:39], v[108:111]
    v_mfma_f32_16x16x32_bf16 v[112:115], a[16:19], v[40:43], v[112:115]
    v_mfma_f32_16x16x32_bf16 v[116:119], a[20:23], v[40:43], v[116:119]
    v_mfma_f32_16x16x32_bf16 v[120:123], a[24:27], v[40:43], v[120:123]
    v_mfma_f32_16x16x32_bf16 v[124:127], a[28:31], v[40:43], v[124:127]
    v_mfma_f32_16x16x32_bf16 v[128:131], a[16:19], v[44:47], v[128:131]
    v_mfma_f32_16x16x32_bf16 v[132:135], a[20:23], v[44:47], v[132:135]
    v_mfma_f32_16x16x32_bf16 v[136:139], a[24:27], v[44:47], v[136:139]
    v_mfma_f32_16x16x32_bf16 v[140:143], a[28:31], v[44:47], v[140:143]
    v_mfma_f32_16x16x32_bf16 v[80:83], a[16:19], v[32:35], v[80:83]
    v_mfma_f32_16x16x32_bf16 v[84:87], a[20:23], v[32:35], v[84:87]
    v_mfma_f32_16x16x32_bf16 v[88:91], a[24:27], v[32:35], v[88:91]
    v_mfma_f32_16x16x32_bf16 v[92:95], a[28:31], v[32:35], v[92:95]
    s_waitcnt vmcnt(4)
    v_mfma_f32_16x16x32_bf16 v[96:99], a[32:35], v[52:55], v[96:99]
    v_mfma_f32_16x16x32_bf16 v[100:103], a[36:39], v[52:55], v[100:103]
    v_mfma_f32_16x16x32_bf16 v[104:107], a[40:43], v[52:55], v[104:107]
    v_mfma_f32_16x16x32_bf16 v[108:111], a[44:47], v[52:55], v[108:111]
    v_mfma_f32_16x16x32_bf16 v[112:115], a[32:35], v[56:59], v[112:115]
    v_mfma_f32_16x16x32_bf16 v[116:119], a[36:39], v[56:59], v[116:119]
    v_mfma_f32_16x16x32_bf16 v[120:123], a[40:43], v[56:59], v[120:123]
    v_mfma_f32_16x16x32_bf16 v[124:127], a[44:47], v[56:59], v[124:127]
    v_mfma_f32_16x16x32_bf16 v[128:131], a[32:35], v[60:63], v[128:131]
    v_mfma_f32_16x16x32_bf16 v[132:135], a[36:39], v[60:63], v[132:135]
    v_mfma_f32_16x16x32_bf16 v[136:139], a[40:43], v[60:63], v[136:139]
    v_mfma_f32_16x16x32_bf16 v[140:143], a[44:47], v[60:63], v[140:143]
    v_mfma_f32_16x16x32_bf16 v[80:83], a[32:35], v[48:51], v[80:83]
    v_mfma_f32_16x16x32_bf16 v[84:87], a[36:39], v[48:51], v[84:87]
    v_mfma_f32_16x16x32_bf16 v[88:91], a[40:43], v[48:51], v[88:91]
    v_mfma_f32_16x16x32_bf16 v[92:95], a[44:47], v[48:51], v[92:95]
    s_waitcnt vmcnt(0)
    v_mfma_f32_16x16x32_bf16 v[96:99], a[48:51], v[68:71], v[96:99]
    v_mfma_f32_16x16x32_bf16 v[100:103], a[52:55], v[68:71], v[100:103]
    v_mfma_f32_16x16x32_bf16 v[104:107], a[56:59], v[68:71], v[104:107]
    v_mfma_f32_16x16x32_bf16 v[108:111], a[60:63], v[68:71], v[108:111]
    v_mfma_f32_16x16x32_bf16 v[112:115], a[48:51], v[72:75], v[112:115]
    v_mfma_f32_16x16x32_bf16 v[116:119], a[52:55], v[72:75], v[116:119]
    v_mfma_f32_16x16x32_bf16 v[120:123], a[56:59], v[72:75], v[120:123]
    v_mfma_f32_16x16x32_bf16 v[124:127], a[60:63], v[72:75], v[124:127]
    v_mfma_f32_16x16x32_bf16 v[128:131], a[48:51], v[76:79], v[128:131]
    v_mfma_f32_16x16x32_bf16 v[132:135], a[52:55], v[76:79], v[132:135]
    v_mfma_f32_16x16x32_bf16 v[136:139], a[56:59], v[76:79], v[136:139]
    v_mfma_f32_16x16x32_bf16 v[140:143], a[60:63], v[76:79], v[140:143]
    v_mfma_f32_16x16x32_bf16 v[80:83], a[48:51], v[64:67], v[80:83]
    v_mfma_f32_16x16x32_bf16 v[84:87], a[52:55], v[64:67], v[84:87]
    v_mfma_f32_16x16x32_bf16 v[88:91], a[56:59], v[64:67], v[88:91]
    v_mfma_f32_16x16x32_bf16 v[92:95], a[60:63], v[64:67], v[92:95]
    s_lshl_b32 s44, s20, 2
    s_add_u32 s44, s44, s3
    s_and_b32 s45, s44, 1
    s_lshr_b32 s44, s44, 1
    s_lshl_b32 s44, s44, 4
    s_lshl_b32 s46, s21, 1
    s_add_u32 s44, s44, s46
    s_lshl_b32 s44, s44, 1
    s_add_u32 s44, s44, s45
    s_lshl_b32 s44, s44, 10
    s_add_u32 s44, s44, 0x1400000
    s_add_u32 s44, s44, s24
    s_lshl_b32 s47, s20, 2
    s_add_u32 s47, s47, s3
    s_lshl_b32 s47, s47, 10
    s_lshl_b32 s31, s21, 7
    s_add_u32 s47, s47, s31
    s_add_u32 s47, s47, s24
    s_add_u32 s47, s47, 0x1dc0000
    s_lshr_b32 s35, s20, 1
    s_and_b32 s36, s20, 1
    s_lshl_b32 s36, s36, 3
    s_add_u32 s36, s36, s21
    ds_write_b128 v208, v[96:99] offset:0
    ds_write_b128 v208, v[100:103] offset:1024
    ds_write_b128 v208, v[104:107] offset:2048
    ds_write_b128 v208, v[108:111] offset:3072
    ds_write_b128 v209, v[112:115] offset:0
    ds_write_b128 v209, v[116:119] offset:1024
    ds_write_b128 v209, v[120:123] offset:2048
    ds_write_b128 v209, v[124:127] offset:3072
    s_nop 3
    ds_write_b128 v210, v[128:131] offset:0
    ds_write_b128 v210, v[132:135] offset:1024
    ds_write_b128 v210, v[136:139] offset:2048
    ds_write_b128 v210, v[140:143] offset:3072
    v_lshlrev_b32 v192, 16, v248
    v_and_b32 v193, 0xffff0000, v248
    v_lshlrev_b32 v194, 16, v249
    v_and_b32 v195, 0xffff0000, v249
    v_lshlrev_b32 v196, 16, v250
    v_and_b32 v197, 0xffff0000, v250
    v_lshlrev_b32 v198, 16, v251
    v_and_b32 v199, 0xffff0000, v251
    v_lshlrev_b32 v200, 16, v252
    v_and_b32 v201, 0xffff0000, v252
    v_lshlrev_b32 v202, 16, v253
    v_and_b32 v203, 0xffff0000, v253
    v_lshlrev_b32 v204, 16, v254
    v_and_b32 v205, 0xffff0000, v254
    v_lshlrev_b32 v206, 16, v255
    v_and_b32 v207, 0xffff0000, v255
    s_waitcnt lgkmcnt(0)
    s_barrier
    ds_read_b128 v[144:147], v211 offset:0
    ds_read_b128 v[148:151], v211 offset:1024
    ds_read_b128 v[152:155], v211 offset:2048
    ds_read_b128 v[156:159], v211 offset:3072
    ds_read_b128 v[160:163], v211 offset:4096
    ds_read_b128 v[164:167], v211 offset:5120
    ds_read_b128 v[168:171], v211 offset:6144
    ds_read_b128 v[172:175], v211 offset:7168
    ds_read_b128 v[176:179], v211 offset:8192
    ds_read_b128 v[180:183], v211 offset:9216
    ds_read_b128 v[184:187], v211 offset:10240
    ds_read_b128 v[188:191], v211 offset:11264
    s_waitcnt lgkmcnt(8)
    v_add_f32 v80, v80, v144
    v_add_f32 v81, v81, v145
    v_add_f32 v82, v82, v146
    v_add_f32 v83, v83, v147
    v_add_f32 v84, v84, v148
    v_add_f32 v85, v85, v149
    v_add_f32 v86, v86, v150
    v_add_f32 v87, v87, v151
    v_add_f32 v88, v88, v152
    v_add_f32 v89, v89, v153
    v_add_f32 v90, v90, v154
    v_add_f32 v91, v91, v155
    v_add_f32 v92, v92, v156
    v_add_f32 v93, v93, v157
    v_add_f32 v94, v94, v158
    v_add_f32 v95, v95, v159
    s_waitcnt lgkmcnt(0)
    v_add_f32 v160, v160, v176
    v_add_f32 v161, v161, v177
    v_add_f32 v162, v162, v178
    v_add_f32 v163, v163, v179
    v_add_f32 v164, v164, v180
    v_add_f32 v165, v165, v181
    v_add_f32 v166, v166, v182
    v_add_f32 v167, v167, v183
    v_add_f32 v168, v168, v184
    v_add_f32 v169, v169, v185
    v_add_f32 v170, v170, v186
    v_add_f32 v171, v171, v187
    v_add_f32 v172, v172, v188
    v_add_f32 v173, v173, v189
    v_add_f32 v174, v174, v190
    v_add_f32 v175, v175, v191
    v_add_f32 v80, v80, v160
    v_add_f32 v81, v81, v161
    v_add_f32 v82, v82, v162
    v_add_f32 v83, v83, v163
    v_add_f32 v84, v84, v164
    v_add_f32 v85, v85, v165
    v_add_f32 v86, v86, v166
    v_add_f32 v87, v87, v167
    v_add_f32 v88, v88, v168
    v_add_f32 v89, v89, v169
    v_add_f32 v90, v90, v170
    v_add_f32 v91, v91, v171
    v_add_f32 v92, v92, v172
    v_add_f32 v93, v93, v173
    v_add_f32 v94, v94, v174
    v_add_f32 v95, v95, v175
    v_add_f32 v80, v80, v192
    v_add_f32 v81, v81, v193
    v_cvt_pk_bf16_f32 v248, v80, v81
    v_add_f32 v82, v82, v194
    v_add_f32 v83, v83, v195
    v_cvt_pk_bf16_f32 v249, v82, v83
    v_add_f32 v84, v84, v196
    v_add_f32 v85, v85, v197
    v_cvt_pk_bf16_f32 v250, v84, v85
    v_add_f32 v86, v86, v198
    v_add_f32 v87, v87, v199
    v_cvt_pk_bf16_f32 v251, v86, v87
    v_add_f32 v88, v88, v200
    v_add_f32 v89, v89, v201
    v_cvt_pk_bf16_f32 v252, v88, v89
    v_add_f32 v90, v90, v202
    v_add_f32 v91, v91, v203
    v_cvt_pk_bf16_f32 v253, v90, v91
    v_add_f32 v92, v92, v204
    v_add_f32 v93, v93, v205
    v_cvt_pk_bf16_f32 v254, v92, v93
    v_add_f32 v94, v94, v206
    v_add_f32 v95, v95, v207
    v_cvt_pk_bf16_f32 v255, v94, v95
    buffer_store_dwordx4 v[248:251], v1, s[8:11], s44 offen sc1
    buffer_store_dwordx4 v[252:255], v1, s[8:11], s44 offen offset:2048 sc1
    v_mov_b32 v206, 0x3f803f80
    v_mov_b32 v202, 0
    v_mov_b32 v203, 0
    v_dot2_f32_bf16 v202, v248, v206, v202
    v_dot2_f32_bf16 v203, v248, v248, v203
    v_dot2_f32_bf16 v202, v249, v206, v202
    v_dot2_f32_bf16 v203, v249, v249, v203
    v_dot2_f32_bf16 v202, v250, v206, v202
    v_dot2_f32_bf16 v203, v250, v250, v203
    v_dot2_f32_bf16 v202, v251, v206, v202
    v_dot2_f32_bf16 v203, v251, v251, v203
    v_dot2_f32_bf16 v202, v252, v206, v202
    v_dot2_f32_bf16 v203, v252, v252, v203
    v_dot2_f32_bf16 v202, v253, v206, v202
    v_dot2_f32_bf16 v203, v253, v253, v203
    v_dot2_f32_bf16 v202, v254, v206, v202
    v_dot2_f32_bf16 v203, v254, v254, v203
    v_dot2_f32_bf16 v202, v255, v206, v202
    v_dot2_f32_bf16 v203, v255, v255, v203
    s_nop 3
    v_mov_b32 v204, v202
    v_mov_b32 v205, v203
    s_nop 1
    v_permlane32_swap_b32 v202, v204
    v_permlane32_swap_b32 v203, v205
    s_nop 1
    v_add_f32 v202, v202, v204
    v_add_f32 v203, v203, v205
    v_mov_b32 v204, v202
    v_mov_b32 v205, v203
    s_nop 1
    v_permlane16_swap_b32 v202, v204
    v_permlane16_swap_b32 v203, v205
    s_nop 1
    v_add_f32 v202, v202, v204
    v_add_f32 v203, v203, v205
    s_mov_b64 exec, 0xffff
    buffer_store_dwordx2 v[202:203], v8, s[8:11], s47 offen sc1
    s_mov_b64 exec, -1
    s_lshl_b32 s40, s35, 8
    s_lshl_b32 s41, s36, 2
    s_add_u32 s40, s40, s41
    s_add_u32 s40, s40, s26
    s_add_u32 s40, s40, 8192
    v_mov_b32 v6, 1
    v_mov_b32 v7, 0
    s_waitcnt vmcnt(0)
    s_barrier
    s_cmp_lg_u32 s3, 0
    s_cbranch_scc1 LSG_5
    s_mov_b64 exec, 1
    buffer_store_dword v6, v7, s[8:11], s40 offen sc1
    s_mov_b64 exec, -1
LSG_5:
    s_add_u32 s52, s51, 0
    s_mov_b32 m0, s52
    s_add_u32 s53, s50, 4096
    buffer_load_dwordx4 v1, s[8:11], s50 offen offset:0 lds
    buffer_load_dwordx4 v1, s[8:11], s50 offen offset:1024 lds
    buffer_load_dwordx4 v1, s[8:11], s50 offen offset:2048 lds
    buffer_load_dwordx4 v1, s[8:11], s50 offen offset:3072 lds
    s_add_u32 s52, s51, 4096
    s_mov_b32 m0, s52
    s_add_u32 s50, s50, 32768
    buffer_load_dwordx4 v1, s[8:11], s53 offen offset:0 lds
    buffer_load_dwordx4 v1, s[8:11], s53 offen offset:1024 lds
    buffer_load_dwordx4 v1, s[8:11], s53 offen offset:2048 lds
    buffer_load_dwordx4 v1, s[8:11], s53 offen offset:3072 lds
    s_add_u32 s52, s51, 32768
    s_mov_b32 m0, s52
    s_add_u32 s53, s50, 4096
    buffer_load_dwordx4 v1, s[8:11], s50 offen offset:0 lds
    buffer_load_dwordx4 v1, s[8:11], s50 offen offset:1024 lds
    buffer_load_dwordx4 v1, s[8:11], s50 offen offset:2048 lds
    buffer_load_dwordx4 v1, s[8:11], s50 offen offset:3072 lds
    s_add_u32 s52, s51, 36864
    s_mov_b32 m0, s52
    s_add_u32 s50, s50, 32768
    buffer_load_dwordx4 v1, s[8:11], s53 offen offset:0 lds
    buffer_load_dwordx4 v1, s[8:11], s53 offen offset:1024 lds
    buffer_load_dwordx4 v1, s[8:11], s53 offen offset:2048 lds
    buffer_load_dwordx4 v1, s[8:11], s53 offen offset:3072 lds
    v_lshlrev_b32 v7, 3, v2
    s_mul_i32 s32, s23, 7168
    s_add_u32 s32, s32, 0x910000
    buffer_load_dwordx2 v[160:161], v7, s[8:11], s32 offen offset:0
    buffer_load_dwordx2 v[162:163], v7, s[8:11], s32 offen offset:512
    buffer_load_dwordx2 v[164:165], v7, s[8:11], s32 offen offset:1024
    buffer_load_dwordx2 v[166:167], v7, s[8:11], s32 offen offset:1536
    buffer_load_dwordx2 v[168:169], v7, s[8:11], s32 offen offset:2048
    buffer_load_dwordx2 v[170:171], v7, s[8:11], s32 offen offset:2560
    buffer_load_dwordx2 v[172:173], v7, s[8:11], s32 offen offset:3072
    buffer_load_dwordx2 v[174:175], v7, s[8:11], s32 offen offset:3584
    s_add_u32 s32, s32, 4096
    buffer_load_dwordx2 v[176:177], v7, s[8:11], s32 offen offset:0
    buffer_load_dwordx2 v[178:179], v7, s[8:11], s32 offen offset:512
    buffer_load_dwordx2 v[180:181], v7, s[8:11], s32 offen offset:1024
    buffer_load_dwordx2 v[182:183], v7, s[8:11], s32 offen offset:1536
    buffer_load_dwordx2 v[184:185], v7, s[8:11], s32 offen offset:2048
    buffer_load_dwordx2 v[186:187], v7, s[8:11], s32 offen offset:2560
    s_lshl_b32 s30, s22, 2
    s_add_u32 s30, s30, s3
    s_lshl_b32 s33, s30, 15
    s_add_u32 s33, s33, 0x1400000
    s_add_u32 s33, s33, s24
    s_lshr_b32 s34, s30, 1
    s_lshl_b32 s34, s34, 4
    s_add_u32 s34, s34, s23
    s_mul_i32 s34, s34, 14
    s_and_b32 s35, s30, 1
    s_add_u32 s36, s34, s35
    s_add_u32 s35, s36, s35
    s_lshl_b32 s35, s35, 10
    s_lshl_b32 s36, s36, 10
    s_add_u32 s35, s35, s24
    s_add_u32 s36, s36, s24
    s_add_u32 s35, s35, 0x1600000
    s_add_u32 s36, s36, 0x1603000
    s_waitcnt vmcnt(0)
    s_cmp_lg_u32 s3, 0
    s_cbranch_scc1 LPO_6
    s_lshl_b32 s40, s22, 8
    s_add_u32 s40, s40, s26
    s_add_u32 s40, s40, 8192
    s_mov_b32 s42, 0xffff
    s_mov_b32 s43, 0
    s_mov_b64 exec, s[42:43]
    s_mov_b32 s41, 0
LPL_6:
    buffer_load_dword v6, v5, s[8:11], s40 offen sc1
    s_add_u32 s41, s41, 1
    s_waitcnt vmcnt(0)
    v_cmp_ne_u32 vcc, 1, v6
    s_cmp_gt_u32 s41, 100000
    s_cbranch_scc1 LPX_6
    s_nop 2
    s_cbranch_vccnz LPL_6
LPX_6:
    s_mov_b64 exec, -1
LPO_6:
    s_barrier
    buffer_load_dwordx4 a[0:3], v1, s[8:11], s33 offen offset:0 sc1
    buffer_load_dwordx4 a[4:7], v1, s[8:11], s33 offen offset:1024 sc1
    buffer_load_dwordx4 a[8:11], v1, s[8:11], s33 offen offset:2048 sc1
    buffer_load_dwordx4 a[12:15], v1, s[8:11], s33 offen offset:3072 sc1
    s_add_u32 s33, s33, 4096
    s_lshl_b32 s31, s30, 11
    s_add_u32 s31, s31, 0x1dc0000
    s_add_u32 s31, s31, s24
    buffer_load_dwordx2 v[188:189], v8, s[8:11], s31 offen offset:0 sc1
    buffer_load_dwordx2 v[190:191], v8, s[8:11], s31 offen offset:128 sc1
    buffer_load_dwordx2 v[192:193], v8, s[8:11], s31 offen offset:1024 sc1
    buffer_load_dwordx2 v[194:195], v8, s[8:11], s31 offen offset:1152 sc1
    buffer_load_dwordx4 a[16:19], v1, s[8:11], s33 offen offset:0 sc1
    buffer_load_dwordx4 a[20:23], v1, s[8:11], s33 offen offset:1024 sc1
    buffer_load_dwordx4 a[24:27], v1, s[8:11], s33 offen offset:2048 sc1
    buffer_load_dwordx4 a[28:31], v1, s[8:11], s33 offen offset:3072 sc1
    s_add_u32 s33, s33, 4096
    buffer_load_dwordx4 a[32:35], v1, s[8:11], s33 offen offset:0 sc1
    buffer_load_dwordx4 a[36:39], v1, s[8:11], s33 offen offset:1024 sc1
    buffer_load_dwordx4 a[40:43], v1, s[8:11], s33 offen offset:2048 sc1
    buffer_load_dwordx4 a[44:47], v1, s[8:11], s33 offen offset:3072 sc1
    s_add_u32 s33, s33, 4096
    buffer_load_dwordx4 a[48:51], v1, s[8:11], s33 offen offset:0 sc1
    buffer_load_dwordx4 a[52:55], v1, s[8:11], s33 offen offset:1024 sc1
    buffer_load_dwordx4 a[56:59], v1, s[8:11], s33 offen offset:2048 sc1
    buffer_load_dwordx4 a[60:63], v1, s[8:11], s33 offen offset:3072 sc1
    s_add_u32 s33, s33, 4096
    ds_read_b128 v[128:131], v14 offset:0
    ds_read_b128 v[132:135], v14 offset:1024
    ds_read_b128 v[136:139], v14 offset:2048
    ds_read_b128 v[140:143], v14 offset:3072
    ds_read_b128 v[144:147], v14 offset:4096
    ds_read_b128 v[148:151], v14 offset:5120
    s_waitcnt vmcnt(18)
    ds_read_b128 v[152:155], v14 offset:6144
    s_waitcnt lgkmcnt(6)
    v_mfma_f32_16x16x32_bf16 v[16:19], v[128:131], a[0:3], 0
    v_mfma_f32_16x16x32_bf16 v[20:23], v[128:131], a[4:7], 0
    ds_read_b128 v[156:159], v14 offset:7168
    s_waitcnt lgkmcnt(6)
    v_mfma_f32_16x16x32_bf16 v[24:27], v[132:135], a[0:3], 0
    v_mfma_f32_16x16x32_bf16 v[28:31], v[132:135], a[4:7], 0
    ds_read_b128 v[128:131], v14 offset:8192
    s_waitcnt lgkmcnt(6)
    v_mfma_f32_16x16x32_bf16 v[32:35], v[136:139], a[0:3], 0
    v_mfma_f32_16x16x32_bf16 v[36:39], v[136:139], a[4:7], 0
    ds_read_b128 v[132:135], v14 offset:9216
    s_waitcnt lgkmcnt(6)
    v_mfma_f32_16x16x32_bf16 v[40:43], v[140:143], a[0:3], 0
    v_mfma_f32_16x16x32_bf16 v[44:47], v[140:143], a[4:7], 0
    buffer_load_dwordx4 a[64:67], v1, s[8:11], s33 offen offset:0 sc1
    buffer_load_dwordx4 a[68:71], v1, s[8:11], s33 offen offset:1024 sc1
    ds_read_b128 v[136:139], v14 offset:10240
    s_waitcnt lgkmcnt(6)
    v_mfma_f32_16x16x32_bf16 v[48:51], v[144:147], a[0:3], 0
    v_mfma_f32_16x16x32_bf16 v[52:55], v[144:147], a[4:7], 0
    ds_read_b128 v[140:143], v14 offset:11264
    s_waitcnt lgkmcnt(6)
    v_mfma_f32_16x16x32_bf16 v[56:59], v[148:151], a[0:3], 0
    v_mfma_f32_16x16x32_bf16 v[60:63], v[148:151], a[4:7], 0
    ds_read_b128 v[144:147], v14 offset:12288
    s_waitcnt lgkmcnt(6)
    v_mfma_f32_16x16x32_bf16 v[64:67], v[152:155], a[0:3], 0
    v_mfma_f32_16x16x32_bf16 v[68:71], v[152:155], a[4:7], 0
    ds_read_b128 v[148:151], v14 offset:13312
    s_waitcnt lgkmcnt(6)
    v_mfma_f32_16x16x32_bf16 v[72:75], v[156:159], a[0:3], 0
    v_mfma_f32_16x16x32_bf16 v[76:79], v[156:159], a[4:7], 0
    s_waitcnt vmcnt(18)
    ds_read_b128 v[152:155], v14 offset:14336
    s_waitcnt lgkmcnt(6)
    v_mfma_f32_16x16x32_bf16 v[16:19], v[128:131], a[8:11], v[16:19]
    v_mfma_f32_16x16x32_bf16 v[20:23], v[128:131], a[12:15], v[20:23]
    ds_read_b128 v[156:159], v14 offset:15360
    s_waitcnt lgkmcnt(6)
    v_mfma_f32_16x16x32_bf16 v[24:27], v[132:135], a[8:11], v[24:27]
    v_mfma_f32_16x16x32_bf16 v[28:31], v[132:135], a[12:15], v[28:31]
    ds_read_b128 v[128:131], v14 offset:16384
    s_waitcnt lgkmcnt(6)
    v_mfma_f32_16x16x32_bf16 v[32:35], v[136:139], a[8:11], v[32:35]
    v_mfma_f32_16x16x32_bf16 v[36:39], v[136:139], a[12:15], v[36:39]
    ds_read_b128 v[132:135], v14 offset:17408
    s_waitcnt lgkmcnt(6)
    v_mfma_f32_16x16x32_bf16 v[40:43], v[140:143], a[8:11], v[40:43]
    v_mfma_f32_16x16x32_bf16 v[44:47], v[140:143], a[12:15], v[44:47]
    buffer_load_dwordx4 a[72:75], v1, s[8:11], s33 offen offset:2048 sc1
    buffer_load_dwordx4 a[76:79], v1, s[8:11], s33 offen offset:3072 sc1
    s_add_u32 s33, s33, 4096
    ds_read_b128 v[136:139], v14 offset:18432
    s_waitcnt lgkmcnt(6)
    v_mfma_f32_16x16x32_bf16 v[48:51], v[144:147], a[8:11], v[48:51]
    v_mfma_f32_16x16x32_bf16 v[52:55], v[144:147], a[12:15], v[52:55]
    ds_read_b128 v[140:143], v14 offset:19456
    s_waitcnt lgkmcnt(6)
    v_mfma_f32_16x16x32_bf16 v[56:59], v[148:151], a[8:11], v[56:59]
    v_mfma_f32_16x16x32_bf16 v[60:63], v[148:151], a[12:15], v[60:63]
    ds_read_b128 v[144:147], v14 offset:20480
    s_waitcnt lgkmcnt(6)
    v_mfma_f32_16x16x32_bf16 v[64:67], v[152:155], a[8:11], v[64:67]
    v_mfma_f32_16x16x32_bf16 v[68:71], v[152:155], a[12:15], v[68:71]
    ds_read_b128 v[148:151], v14 offset:21504
    s_waitcnt lgkmcnt(6)
    v_mfma_f32_16x16x32_bf16 v[72:75], v[156:159], a[8:11], v[72:75]
    v_mfma_f32_16x16x32_bf16 v[76:79], v[156:159], a[12:15], v[76:79]
    s_waitcnt vmcnt(14)
    ds_read_b128 v[152:155], v14 offset:22528
    s_waitcnt lgkmcnt(6)
    v_mfma_f32_16x16x32_bf16 v[16:19], v[128:131], a[16:19], v[16:19]
    v_mfma_f32_16x16x32_bf16 v[20:23], v[128:131], a[20:23], v[20:23]
    ds_read_b128 v[156:159], v14 offset:23552
    s_waitcnt lgkmcnt(6)
    v_mfma_f32_16x16x32_bf16 v[24:27], v[132:135], a[16:19], v[24:27]
    v_mfma_f32_16x16x32_bf16 v[28:31], v[132:135], a[20:23], v[28:31]
    ds_read_b128 v[128:131], v14 offset:24576
    s_waitcnt lgkmcnt(6)
    v_mfma_f32_16x16x32_bf16 v[32:35], v[136:139], a[16:19], v[32:35]
    v_mfma_f32_16x16x32_bf16 v[36:39], v[136:139], a[20:23], v[36:39]
    ds_read_b128 v[132:135], v14 offset:25600
    s_waitcnt lgkmcnt(6)
    v_mfma_f32_16x16x32_bf16 v[40:43], v[140:143], a[16:19], v[40:43]
    v_mfma_f32_16x16x32_bf16 v[44:47], v[140:143], a[20:23], v[44:47]
    buffer_load_dwordx4 a[80:83], v1, s[8:11], s33 offen offset:0 sc1
    buffer_load_dwordx4 a[84:87], v1, s[8:11], s33 offen offset:1024 sc1
    ds_read_b128 v[136:139], v14 offset:26624
    s_waitcnt lgkmcnt(6)
    v_mfma_f32_16x16x32_bf16 v[48:51], v[144:147], a[16:19], v[48:51]
    v_mfma_f32_16x16x32_bf16 v[52:55], v[144:147], a[20:23], v[52:55]
    ds_read_b128 v[140:143], v14 offset:27648
    s_waitcnt lgkmcnt(6)
    v_mfma_f32_16x16x32_bf16 v[56:59], v[148:151], a[16:19], v[56:59]
    v_mfma_f32_16x16x32_bf16 v[60:63], v[148:151], a[20:23], v[60:63]
    ds_read_b128 v[144:147], v14 offset:28672
    s_waitcnt lgkmcnt(6)
    v_mfma_f32_16x16x32_bf16 v[64:67], v[152:155], a[16:19], v[64:67]
    v_mfma_f32_16x16x32_bf16 v[68:71], v[152:155], a[20:23], v[68:71]
    ds_read_b128 v[148:151], v14 offset:29696
    s_waitcnt lgkmcnt(6)
    v_mfma_f32_16x16x32_bf16 v[72:75], v[156:159], a[16:19], v[72:75]
    v_mfma_f32_16x16x32_bf16 v[76:79], v[156:159], a[20:23], v[76:79]
    s_waitcnt vmcnt(14)
    ds_read_b128 v[152:155], v14 offset:30720
    s_waitcnt lgkmcnt(6)
    v_mfma_f32_16x16x32_bf16 v[16:19], v[128:131], a[24:27], v[16:19]
    v_mfma_f32_16x16x32_bf16 v[20:23], v[128:131], a[28:31], v[20:23]
    ds_read_b128 v[156:159], v14 offset:31744
    s_waitcnt lgkmcnt(6)
    v_mfma_f32_16x16x32_bf16 v[24:27], v[132:135], a[24:27], v[24:27]
    v_mfma_f32_16x16x32_bf16 v[28:31], v[132:135], a[28:31], v[28:31]
    ds_read_b128 v[128:131], v14 offset:32768
    s_waitcnt lgkmcnt(6)
    v_mfma_f32_16x16x32_bf16 v[32:35], v[136:139], a[24:27], v[32:35]
    v_mfma_f32_16x16x32_bf16 v[36:39], v[136:139], a[28:31], v[36:39]
    ds_read_b128 v[132:135], v14 offset:33792
    s_waitcnt lgkmcnt(6)
    v_mfma_f32_16x16x32_bf16 v[40:43], v[140:143], a[24:27], v[40:43]
    v_mfma_f32_16x16x32_bf16 v[44:47], v[140:143], a[28:31], v[44:47]
    buffer_load_dwordx4 a[88:91], v1, s[8:11], s33 offen offset:2048 sc1
    buffer_load_dwordx4 a[92:95], v1, s[8:11], s33 offen offset:3072 sc1
    s_add_u32 s33, s33, 4096
    ds_read_b128 v[136:139], v14 offset:34816
    s_waitcnt lgkmcnt(6)
    v_mfma_f32_16x16x32_bf16 v[48:51], v[144:147], a[24:27], v[48:51]
    v_mfma_f32_16x16x32_bf16 v[52:55], v[144:147], a[28:31], v[52:55]
    ds_read_b128 v[140:143], v14 offset:35840
    s_waitcnt lgkmcnt(6)
    v_mfma_f32_16x16x32_bf16 v[56:59], v[148:151], a[24:27], v[56:59]
    v_mfma_f32_16x16x32_bf16 v[60:63], v[148:151], a[28:31], v[60:63]
    ds_read_b128 v[144:147], v14 offset:36864
    s_waitcnt lgkmcnt(6)
    v_mfma_f32_16x16x32_bf16 v[64:67], v[152:155], a[24:27], v[64:67]
    v_mfma_f32_16x16x32_bf16 v[68:71], v[152:155], a[28:31], v[68:71]
    ds_read_b128 v[148:151], v14 offset:37888
    s_waitcnt lgkmcnt(6)
    v_mfma_f32_16x16x32_bf16 v[72:75], v[156:159], a[24:27], v[72:75]
    v_mfma_f32_16x16x32_bf16 v[76:79], v[156:159], a[28:31], v[76:79]
    s_waitcnt vmcnt(14)
    ds_read_b128 v[152:155], v14 offset:38912
    s_waitcnt lgkmcnt(6)
    v_mfma_f32_16x16x32_bf16 v[16:19], v[128:131], a[32:35], v[16:19]
    v_mfma_f32_16x16x32_bf16 v[20:23], v[128:131], a[36:39], v[20:23]
    ds_read_b128 v[156:159], v14 offset:39936
    s_waitcnt lgkmcnt(6)
    v_mfma_f32_16x16x32_bf16 v[24:27], v[132:135], a[32:35], v[24:27]
    v_mfma_f32_16x16x32_bf16 v[28:31], v[132:135], a[36:39], v[28:31]
    ds_read_b128 v[128:131], v14 offset:40960
    s_waitcnt lgkmcnt(6)
    v_mfma_f32_16x16x32_bf16 v[32:35], v[136:139], a[32:35], v[32:35]
    v_mfma_f32_16x16x32_bf16 v[36:39], v[136:139], a[36:39], v[36:39]
    ds_read_b128 v[132:135], v14 offset:41984
    s_waitcnt lgkmcnt(6)
    v_mfma_f32_16x16x32_bf16 v[40:43], v[140:143], a[32:35], v[40:43]
    v_mfma_f32_16x16x32_bf16 v[44:47], v[140:143], a[36:39], v[44:47]
    buffer_load_dwordx4 a[96:99], v1, s[8:11], s33 offen offset:0 sc1
    buffer_load_dwordx4 a[100:103], v1, s[8:11], s33 offen offset:1024 sc1
    ds_read_b128 v[136:139], v14 offset:43008
    s_waitcnt lgkmcnt(6)
    v_mfma_f32_16x16x32_bf16 v[48:51], v[144:147], a[32:35], v[48:51]
    v_mfma_f32_16x16x32_bf16 v[52:55], v[144:147], a[36:39], v[52:55]
    ds_read_b128 v[140:143], v14 offset:44032
    s_waitcnt lgkmcnt(6)
    v_mfma_f32_16x16x32_bf16 v[56:59], v[148:151], a[32:35], v[56:59]
    v_mfma_f32_16x16x32_bf16 v[60:63], v[148:151], a[36:39], v[60:63]
    ds_read_b128 v[144:147], v14 offset:45056
    s_waitcnt lgkmcnt(6)
    v_mfma_f32_16x16x32_bf16 v[64:67], v[152:155], a[32:35], v[64:67]
    v_mfma_f32_16x16x32_bf16 v[68:71], v[152:155], a[36:39], v[68:71]
    ds_read_b128 v[148:151], v14 offset:46080
    s_waitcnt lgkmcnt(6)
    v_mfma_f32_16x16x32_bf16 v[72:75], v[156:159], a[32:35], v[72:75]
    v_mfma_f32_16x16x32_bf16 v[76:79], v[156:159], a[36:39], v[76:79]
    s_waitcnt vmcnt(14)
    ds_read_b128 v[152:155], v14 offset:47104
    s_waitcnt lgkmcnt(6)
    v_mfma_f32_16x16x32_bf16 v[16:19], v[128:131], a[40:43], v[16:19]
    v_mfma_f32_16x16x32_bf16 v[20:23], v[128:131], a[44:47], v[20:23]
    v_add_f32 v188, v188, v190
    v_add_f32 v189, v189, v191
    v_add_f32 v192, v192, v194
    v_add_f32 v193, v193, v195
    v_mov_b32 v204, v188
    v_mov_b32 v205, v189
    v_mov_b32 v206, v192
    v_mov_b32 v207, v193
    s_nop 1
    v_permlane32_swap_b32 v188, v204
    v_permlane32_swap_b32 v189, v205
    v_permlane32_swap_b32 v192, v206
    v_permlane32_swap_b32 v193, v207
    s_nop 1
    v_add_f32 v188, v188, v204
    v_add_f32 v189, v189, v205
    v_add_f32 v192, v192, v206
    v_add_f32 v193, v193, v207
    v_mov_b32 v204, v188
    v_mov_b32 v205, v189
    v_mov_b32 v206, v192
    v_mov_b32 v207, v193
    s_nop 1
    v_permlane16_swap_b32 v188, v204
    v_permlane16_swap_b32 v189, v205
    v_permlane16_swap_b32 v192, v206
    v_permlane16_swap_b32 v193, v207
    s_nop 1
    v_add_f32 v188, v188, v204
    v_add_f32 v189, v189, v205
    v_add_f32 v192, v192, v206
    v_add_f32 v193, v193, v207
    v_mul_f32 v196, 0xbb000000, v188
    v_mul_f32 v190, v196, v196
    v_mov_b32 v191, 0x3b000000
    v_fma_f32 v190, v189, v191, -v190
    v_max_f32 v190, 0, v190
    v_add_f32 v190, 0x3727c5ac, v190
    v_rsq_f32 v198, v190
    v_mul_f32 v197, 0xbb000000, v192
    v_mul_f32 v194, v197, v197
    v_mov_b32 v195, 0x3b000000
    v_fma_f32 v194, v193, v195, -v194
    v_max_f32 v194, 0, v194
    v_add_f32 v194, 0x3727c5ac, v194
    v_rsq_f32 v199, v194
    s_nop 0
    v_and_b32 v204, 0xffff0000, v196
    v_sub_f32 v205, v196, v204
    v_lshrrev_b32 v201, 16, v204
    v_cvt_pk_bf16_f32 v200, v204, v205
    v_and_b32 v204, 0xffff0000, v197
    v_sub_f32 v205, v197, v204
    v_lshrrev_b32 v203, 16, v204
    v_cvt_pk_bf16_f32 v202, v204, v205
    ds_read_b128 v[156:159], v14 offset:48128
    s_waitcnt lgkmcnt(6)
    v_mfma_f32_16x16x32_bf16 v[24:27], v[132:135], a[40:43], v[24:27]
    v_mfma_f32_16x16x32_bf16 v[28:31], v[132:135], a[44:47], v[28:31]
    ds_read_b128 v[128:131], v14 offset:49152
    s_waitcnt lgkmcnt(6)
    v_mfma_f32_16x16x32_bf16 v[32:35], v[136:139], a[40:43], v[32:35]
    v_mfma_f32_16x16x32_bf16 v[36:39], v[136:139], a[44:47], v[36:39]
    ds_read_b128 v[132:135], v14 offset:50176
    s_waitcnt lgkmcnt(6)
    v_mfma_f32_16x16x32_bf16 v[40:43], v[140:143], a[40:43], v[40:43]
    v_mfma_f32_16x16x32_bf16 v[44:47], v[140:143], a[44:47], v[44:47]
    buffer_load_dwordx4 a[104:107], v1, s[8:11], s33 offen offset:2048 sc1
    buffer_load_dwordx4 a[108:111], v1, s[8:11], s33 offen offset:3072 sc1
    s_add_u32 s33, s33, 4096
    ds_read_b128 v[136:139], v14 offset:51200
    s_waitcnt lgkmcnt(6)
    v_mfma_f32_16x16x32_bf16 v[48:51], v[144:147], a[40:43], v[48:51]
    v_mfma_f32_16x16x32_bf16 v[52:55], v[144:147], a[44:47], v[52:55]
    ds_read_b128 v[140:143], v14 offset:52224
    s_waitcnt lgkmcnt(6)
    v_mfma_f32_16x16x32_bf16 v[56:59], v[148:151], a[40:43], v[56:59]
    v_mfma_f32_16x16x32_bf16 v[60:63], v[148:151], a[44:47], v[60:63]
    ds_read_b128 v[144:147], v14 offset:53248
    s_waitcnt lgkmcnt(6)
    v_mfma_f32_16x16x32_bf16 v[64:67], v[152:155], a[40:43], v[64:67]
    v_mfma_f32_16x16x32_bf16 v[68:71], v[152:155], a[44:47], v[68:71]
    ds_read_b128 v[148:151], v14 offset:54272
    s_waitcnt lgkmcnt(6)
    v_mfma_f32_16x16x32_bf16 v[72:75], v[156:159], a[40:43], v[72:75]
    v_mfma_f32_16x16x32_bf16 v[76:79], v[156:159], a[44:47], v[76:79]
    s_waitcnt vmcnt(14)
    ds_read_b128 v[152:155], v14 offset:55296
    s_waitcnt lgkmcnt(6)
    v_mfma_f32_16x16x32_bf16 v[16:19], v[128:131], a[48:51], v[16:19]
    v_mfma_f32_16x16x32_bf16 v[20:23], v[128:131], a[52:55], v[20:23]
    ds_read_b128 v[156:159], v14 offset:56320
    s_waitcnt lgkmcnt(6)
    v_mfma_f32_16x16x32_bf16 v[24:27], v[132:135], a[48:51], v[24:27]
    v_mfma_f32_16x16x32_bf16 v[28:31], v[132:135], a[52:55], v[28:31]
    ds_read_b128 v[128:131], v14 offset:57344
    s_waitcnt lgkmcnt(6)
    v_mfma_f32_16x16x32_bf16 v[32:35], v[136:139], a[48:51], v[32:35]
    v_mfma_f32_16x16x32_bf16 v[36:39], v[136:139], a[52:55], v[36:39]
    ds_read_b128 v[132:135], v14 offset:58368
    s_waitcnt lgkmcnt(6)
    v_mfma_f32_16x16x32_bf16 v[40:43], v[140:143], a[48:51], v[40:43]
    v_mfma_f32_16x16x32_bf16 v[44:47], v[140:143], a[52:55], v[44:47]
    buffer_load_dwordx4 a[112:115], v1, s[8:11], s33 offen offset:0 sc1
    buffer_load_dwordx4 a[116:119], v1, s[8:11], s33 offen offset:1024 sc1
    ds_read_b128 v[136:139], v14 offset:59392
    s_waitcnt lgkmcnt(6)
    v_mfma_f32_16x16x32_bf16 v[48:51], v[144:147], a[48:51], v[48:51]
    v_mfma_f32_16x16x32_bf16 v[52:55], v[144:147], a[52:55], v[52:55]
    ds_read_b128 v[140:143], v14 offset:60416
    s_waitcnt lgkmcnt(6)
    v_mfma_f32_16x16x32_bf16 v[56:59], v[148:151], a[48:51], v[56:59]
    v_mfma_f32_16x16x32_bf16 v[60:63], v[148:151], a[52:55], v[60:63]
    ds_read_b128 v[144:147], v14 offset:61440
    s_waitcnt lgkmcnt(6)
    v_mfma_f32_16x16x32_bf16 v[64:67], v[152:155], a[48:51], v[64:67]
    v_mfma_f32_16x16x32_bf16 v[68:71], v[152:155], a[52:55], v[68:71]
    ds_read_b128 v[148:151], v14 offset:62464
    s_waitcnt lgkmcnt(6)
    v_mfma_f32_16x16x32_bf16 v[72:75], v[156:159], a[48:51], v[72:75]
    v_mfma_f32_16x16x32_bf16 v[76:79], v[156:159], a[52:55], v[76:79]
    s_waitcnt vmcnt(14)
    ds_read_b128 v[152:155], v14 offset:63488
    s_waitcnt lgkmcnt(6)
    v_mfma_f32_16x16x32_bf16 v[16:19], v[128:131], a[56:59], v[16:19]
    v_mfma_f32_16x16x32_bf16 v[20:23], v[128:131], a[60:63], v[20:23]
    ds_read_b128 v[156:159], v14 offset:64512
    s_waitcnt lgkmcnt(6)
    v_mfma_f32_16x16x32_bf16 v[24:27], v[132:135], a[56:59], v[24:27]
    v_mfma_f32_16x16x32_bf16 v[28:31], v[132:135], a[60:63], v[28:31]
    s_barrier
    s_add_u32 s52, s51, 65536
    s_mov_b32 m0, s52
    s_add_u32 s53, s50, 4096
    buffer_load_dwordx4 v1, s[8:11], s50 offen offset:0 lds
    buffer_load_dwordx4 v1, s[8:11], s50 offen offset:1024 lds
    buffer_load_dwordx4 v1, s[8:11], s50 offen offset:2048 lds
    buffer_load_dwordx4 v1, s[8:11], s50 offen offset:3072 lds
    s_add_u32 s52, s51, 69632
    s_mov_b32 m0, s52
    s_add_u32 s50, s50, 32768
    buffer_load_dwordx4 v1, s[8:11], s53 offen offset:0 lds
    buffer_load_dwordx4 v1, s[8:11], s53 offen offset:1024 lds
    buffer_load_dwordx4 v1, s[8:11], s53 offen offset:2048 lds
    buffer_load_dwordx4 v1, s[8:11], s53 offen offset:3072 lds
    ds_read_b128 v[128:131], v15 offset:0
    s_waitcnt lgkmcnt(6)
    v_mfma_f32_16x16x32_bf16 v[32:35], v[136:139], a[56:59], v[32:35]
    v_mfma_f32_16x16x32_bf16 v[36:39], v[136:139], a[60:63], v[36:39]
    ds_read_b128 v[132:135], v15 offset:1024
    s_waitcnt lgkmcnt(6)
    v_mfma_f32_16x16x32_bf16 v[40:43], v[140:143], a[56:59], v[40:43]
    v_mfma_f32_16x16x32_bf16 v[44:47], v[140:143], a[60:63], v[44:47]
    buffer_load_dwordx4 a[120:123], v1, s[8:11], s33 offen offset:2048 sc1
    buffer_load_dwordx4 a[124:127], v1, s[8:11], s33 offen offset:3072 sc1
    s_add_u32 s33, s33, 4096
    ds_read_b128 v[136:139], v15 offset:2048
    s_waitcnt lgkmcnt(6)
    v_mfma_f32_16x16x32_bf16 v[48:51], v[144:147], a[56:59], v[48:51]
    v_mfma_f32_16x16x32_bf16 v[52:55], v[144:147], a[60:63], v[52:55]
    ds_read_b128 v[140:143], v15 offset:3072
    s_waitcnt lgkmcnt(6)
    v_mfma_f32_16x16x32_bf16 v[56:59], v[148:151], a[56:59], v[56:59]
    v_mfma_f32_16x16x32_bf16 v[60:63], v[148:151], a[60:63], v[60:63]
    ds_read_b128 v[144:147], v15 offset:4096
    s_waitcnt lgkmcnt(6)
    v_mfma_f32_16x16x32_bf16 v[64:67], v[152:155], a[56:59], v[64:67]
    v_mfma_f32_16x16x32_bf16 v[68:71], v[152:155], a[60:63], v[68:71]
    ds_read_b128 v[148:151], v15 offset:5120
    s_waitcnt lgkmcnt(6)
    v_mfma_f32_16x16x32_bf16 v[72:75], v[156:159], a[56:59], v[72:75]
    v_mfma_f32_16x16x32_bf16 v[76:79], v[156:159], a[60:63], v[76:79]
    s_waitcnt vmcnt(22)
    ds_read_b128 v[152:155], v15 offset:6144
    s_waitcnt lgkmcnt(6)
    v_mfma_f32_16x16x32_bf16 v[16:19], v[128:131], a[64:67], v[16:19]
    v_mfma_f32_16x16x32_bf16 v[20:23], v[128:131], a[68:71], v[20:23]
    ds_read_b128 v[156:159], v15 offset:7168
    s_waitcnt lgkmcnt(6)
    v_mfma_f32_16x16x32_bf16 v[24:27], v[132:135], a[64:67], v[24:27]
    v_mfma_f32_16x16x32_bf16 v[28:31], v[132:135], a[68:71], v[28:31]
    ds_read_b128 v[128:131], v15 offset:8192
    s_waitcnt lgkmcnt(6)
    v_mfma_f32_16x16x32_bf16 v[32:35], v[136:139], a[64:67], v[32:35]
    v_mfma_f32_16x16x32_bf16 v[36:39], v[136:139], a[68:71], v[36:39]
    ds_read_b128 v[132:135], v15 offset:9216
    s_waitcnt lgkmcnt(6)
    v_mfma_f32_16x16x32_bf16 v[40:43], v[140:143], a[64:67], v[40:43]
    v_mfma_f32_16x16x32_bf16 v[44:47], v[140:143], a[68:71], v[44:47]
    ds_read_b128 v[136:139], v15 offset:10240
    s_waitcnt lgkmcnt(6)
    v_mfma_f32_16x16x32_bf16 v[48:51], v[144:147], a[64:67], v[48:51]
    v_mfma_f32_16x16x32_bf16 v[52:55], v[144:147], a[68:71], v[52:55]
    ds_read_b128 v[140:143], v15 offset:11264
    s_waitcnt lgkmcnt(6)
    v_mfma_f32_16x16x32_bf16 v[56:59], v[148:151], a[64:67], v[56:59]
    v_mfma_f32_16x16x32_bf16 v[60:63], v[148:151], a[68:71], v[60:63]
    ds_read_b128 v[144:147], v15 offset:12288
    s_waitcnt lgkmcnt(6)
    v_mfma_f32_16x16x32_bf16 v[64:67], v[152:155], a[64:67], v[64:67]
    v_mfma_f32_16x16x32_bf16 v[68:71], v[152:155], a[68:71], v[68:71]
    ds_read_b128 v[148:151], v15 offset:13312
    s_waitcnt lgkmcnt(6)
    v_mfma_f32_16x16x32_bf16 v[72:75], v[156:159], a[64:67], v[72:75]
    v_mfma_f32_16x16x32_bf16 v[76:79], v[156:159], a[68:71], v[76:79]
    s_waitcnt vmcnt(20)
    ds_read_b128 v[152:155], v15 offset:14336
    s_waitcnt lgkmcnt(6)
    v_mfma_f32_16x16x32_bf16 v[16:19], v[128:131], a[72:75], v[16:19]
    v_mfma_f32_16x16x32_bf16 v[20:23], v[128:131], a[76:79], v[20:23]
    ds_read_b128 v[156:159], v15 offset:15360
    s_waitcnt lgkmcnt(6)
    v_mfma_f32_16x16x32_bf16 v[24:27], v[132:135], a[72:75], v[24:27]
    v_mfma_f32_16x16x32_bf16 v[28:31], v[132:135], a[76:79], v[28:31]
    ds_read_b128 v[128:131], v15 offset:16384
    s_waitcnt lgkmcnt(6)
    v_mfma_f32_16x16x32_bf16 v[32:35], v[136:139], a[72:75], v[32:35]
    v_mfma_f32_16x16x32_bf16 v[36:39], v[136:139], a[76:79], v[36:39]
    ds_read_b128 v[132:135], v15 offset:17408
    s_waitcnt lgkmcnt(6)
    v_mfma_f32_16x16x32_bf16 v[40:43], v[140:143], a[72:75], v[40:43]
    v_mfma_f32_16x16x32_bf16 v[44:47], v[140:143], a[76:79], v[44:47]
    ds_read_b128 v[136:139], v15 offset:18432
    s_waitcnt lgkmcnt(6)
    v_mfma_f32_16x16x32_bf16 v[48:51], v[144:147], a[72:75], v[48:51]
    v_mfma_f32_16x16x32_bf16 v[52:55], v[144:147], a[76:79], v[52:55]
    ds_read_b128 v[140:143], v15 offset:19456
    s_waitcnt lgkmcnt(6)
    v_mfma_f32_16x16x32_bf16 v[56:59], v[148:151], a[72:75], v[56:59]
    v_mfma_f32_16x16x32_bf16 v[60:63], v[148:151], a[76:79], v[60:63]
    ds_read_b128 v[144:147], v15 offset:20480
    s_waitcnt lgkmcnt(6)
    v_mfma_f32_16x16x32_bf16 v[64:67], v[152:155], a[72:75], v[64:67]
    v_mfma_f32_16x16x32_bf16 v[68:71], v[152:155], a[76:79], v[68:71]
    ds_read_b128 v[148:151], v15 offset:21504
    s_waitcnt lgkmcnt(6)
    v_mfma_f32_16x16x32_bf16 v[72:75], v[156:159], a[72:75], v[72:75]
    v_mfma_f32_16x16x32_bf16 v[76:79], v[156:159], a[76:79], v[76:79]
    s_waitcnt vmcnt(18)
    ds_read_b128 v[152:155], v15 offset:22528
    s_waitcnt lgkmcnt(6)
    v_mfma_f32_16x16x32_bf16 v[16:19], v[128:131], a[80:83], v[16:19]
    v_mfma_f32_16x16x32_bf16 v[20:23], v[128:131], a[84:87], v[20:23]
    ds_read_b128 v[156:159], v15 offset:23552
    s_waitcnt lgkmcnt(6)
    v_mfma_f32_16x16x32_bf16 v[24:27], v[132:135], a[80:83], v[24:27]
    v_mfma_f32_16x16x32_bf16 v[28:31], v[132:135], a[84:87], v[28:31]
    ds_read_b128 v[128:131], v15 offset:24576
    s_waitcnt lgkmcnt(6)
    v_mfma_f32_16x16x32_bf16 v[32:35], v[136:139], a[80:83], v[32:35]
    v_mfma_f32_16x16x32_bf16 v[36:39], v[136:139], a[84:87], v[36:39]
    ds_read_b128 v[132:135], v15 offset:25600
    s_waitcnt lgkmcnt(6)
    v_mfma_f32_16x16x32_bf16 v[40:43], v[140:143], a[80:83], v[40:43]
    v_mfma_f32_16x16x32_bf16 v[44:47], v[140:143], a[84:87], v[44:47]
    ds_read_b128 v[136:139], v15 offset:26624
    s_waitcnt lgkmcnt(6)
    v_mfma_f32_16x16x32_bf16 v[48:51], v[144:147], a[80:83], v[48:51]
    v_mfma_f32_16x16x32_bf16 v[52:55], v[144:147], a[84:87], v[52:55]
    ds_read_b128 v[140:143], v15 offset:27648
    s_waitcnt lgkmcnt(6)
    v_mfma_f32_16x16x32_bf16 v[56:59], v[148:151], a[80:83], v[56:59]
    v_mfma_f32_16x16x32_bf16 v[60:63], v[148:151], a[84:87], v[60:63]
    ds_read_b128 v[144:147], v15 offset:28672
    s_waitcnt lgkmcnt(6)
    v_mfma_f32_16x16x32_bf16 v[64:67], v[152:155], a[80:83], v[64:67]
    v_mfma_f32_16x16x32_bf16 v[68:71], v[152:155], a[84:87], v[68:71]
    ds_read_b128 v[148:151], v15 offset:29696
    s_waitcnt lgkmcnt(6)
    v_mfma_f32_16x16x32_bf16 v[72:75], v[156:159], a[80:83], v[72:75]
    v_mfma_f32_16x16x32_bf16 v[76:79], v[156:159], a[84:87], v[76:79]
    s_waitcnt vmcnt(16)
    ds_read_b128 v[152:155], v15 offset:30720
    s_waitcnt lgkmcnt(6)
    v_mfma_f32_16x16x32_bf16 v[16:19], v[128:131], a[88:91], v[16:19]
    v_mfma_f32_16x16x32_bf16 v[20:23], v[128:131], a[92:95], v[20:23]
    ds_read_b128 v[156:159], v15 offset:31744
    s_waitcnt lgkmcnt(6)
    v_mfma_f32_16x16x32_bf16 v[24:27], v[132:135], a[88:91], v[24:27]
    v_mfma_f32_16x16x32_bf16 v[28:31], v[132:135], a[92:95], v[28:31]
    s_barrier
    s_add_u32 s52, s51, 98304
    s_mov_b32 m0, s52
    s_add_u32 s53, s50, 4096
    buffer_load_dwordx4 v1, s[8:11], s50 offen offset:0 lds
    buffer_load_dwordx4 v1, s[8:11], s50 offen offset:1024 lds
    buffer_load_dwordx4 v1, s[8:11], s50 offen offset:2048 lds
    buffer_load_dwordx4 v1, s[8:11], s50 offen offset:3072 lds
    s_add_u32 s52, s51, 102400
    s_mov_b32 m0, s52
    s_add_u32 s50, s50, 32768
    buffer_load_dwordx4 v1, s[8:11], s53 offen offset:0 lds
    buffer_load_dwordx4 v1, s[8:11], s53 offen offset:1024 lds
    buffer_load_dwordx4 v1, s[8:11], s53 offen offset:2048 lds
    buffer_load_dwordx4 v1, s[8:11], s53 offen offset:3072 lds
    ds_read_b128 v[128:131], v1 offset:0
    s_waitcnt lgkmcnt(6)
    v_mfma_f32_16x16x32_bf16 v[32:35], v[136:139], a[88:91], v[32:35]
    v_mfma_f32_16x16x32_bf16 v[36:39], v[136:139], a[92:95], v[36:39]
    ds_read_b128 v[132:135], v1 offset:1024
    s_waitcnt lgkmcnt(6)
    v_mfma_f32_16x16x32_bf16 v[40:43], v[140:143], a[88:91], v[40:43]
    v_mfma_f32_16x16x32_bf16 v[44:47], v[140:143], a[92:95], v[44:47]
    ds_read_b128 v[136:139], v1 offset:2048
    s_waitcnt lgkmcnt(6)
    v_mfma_f32_16x16x32_bf16 v[48:51], v[144:147], a[88:91], v[48:51]
    v_mfma_f32_16x16x32_bf16 v[52:55], v[144:147], a[92:95], v[52:55]
    ds_read_b128 v[140:143], v1 offset:3072
    s_waitcnt lgkmcnt(6)
    v_mfma_f32_16x16x32_bf16 v[56:59], v[148:151], a[88:91], v[56:59]
    v_mfma_f32_16x16x32_bf16 v[60:63], v[148:151], a[92:95], v[60:63]
    ds_read_b128 v[144:147], v1 offset:4096
    s_waitcnt lgkmcnt(6)
    v_mfma_f32_16x16x32_bf16 v[64:67], v[152:155], a[88:91], v[64:67]
    v_mfma_f32_16x16x32_bf16 v[68:71], v[152:155], a[92:95], v[68:71]
    ds_read_b128 v[148:151], v1 offset:5120
    s_waitcnt lgkmcnt(6)
    v_mfma_f32_16x16x32_bf16 v[72:75], v[156:159], a[88:91], v[72:75]
    v_mfma_f32_16x16x32_bf16 v[76:79], v[156:159], a[92:95], v[76:79]
    s_waitcnt vmcnt(22)
    ds_read_b128 v[152:155], v1 offset:6144
    s_waitcnt lgkmcnt(6)
    v_mfma_f32_16x16x32_bf16 v[16:19], v[128:131], a[96:99], v[16:19]
    v_mfma_f32_16x16x32_bf16 v[20:23], v[128:131], a[100:103], v[20:23]
    ds_read_b128 v[156:159], v1 offset:7168
    s_waitcnt lgkmcnt(6)
    v_mfma_f32_16x16x32_bf16 v[24:27], v[132:135], a[96:99], v[24:27]
    v_mfma_f32_16x16x32_bf16 v[28:31], v[132:135], a[100:103], v[28:31]
    ds_read_b128 v[128:131], v1 offset:8192
    s_waitcnt lgkmcnt(6)
    v_mfma_f32_16x16x32_bf16 v[32:35], v[136:139], a[96:99], v[32:35]
    v_mfma_f32_16x16x32_bf16 v[36:39], v[136:139], a[100:103], v[36:39]
    ds_read_b128 v[132:135], v1 offset:9216
    s_waitcnt lgkmcnt(6)
    v_mfma_f32_16x16x32_bf16 v[40:43], v[140:143], a[96:99], v[40:43]
    v_mfma_f32_16x16x32_bf16 v[44:47], v[140:143], a[100:103], v[44:47]
    ds_read_b128 v[136:139], v1 offset:10240
    s_waitcnt lgkmcnt(6)
    v_mfma_f32_16x16x32_bf16 v[48:51], v[144:147], a[96:99], v[48:51]
    v_mfma_f32_16x16x32_bf16 v[52:55], v[144:147], a[100:103], v[52:55]
    ds_read_b128 v[140:143], v1 offset:11264
    s_waitcnt lgkmcnt(6)
    v_mfma_f32_16x16x32_bf16 v[56:59], v[148:151], a[96:99], v[56:59]
    v_mfma_f32_16x16x32_bf16 v[60:63], v[148:151], a[100:103], v[60:63]
    ds_read_b128 v[144:147], v1 offset:12288
    s_waitcnt lgkmcnt(6)
    v_mfma_f32_16x16x32_bf16 v[64:67], v[152:155], a[96:99], v[64:67]
    v_mfma_f32_16x16x32_bf16 v[68:71], v[152:155], a[100:103], v[68:71]
    buffer_load_dwordx4 a[128:131], v1, s[8:11], s54 offen offset:0
    ds_read_b128 v[148:151], v1 offset:13312
    s_waitcnt lgkmcnt(6)
    v_mfma_f32_16x16x32_bf16 v[72:75], v[156:159], a[96:99], v[72:75]
    v_mfma_f32_16x16x32_bf16 v[76:79], v[156:159], a[100:103], v[76:79]
    s_waitcnt vmcnt(21)
    ds_read_b128 v[152:155], v1 offset:14336
    s_waitcnt lgkmcnt(6)
    v_mfma_f32_16x16x32_bf16 v[16:19], v[128:131], a[104:107], v[16:19]
    v_mfma_f32_16x16x32_bf16 v[20:23], v[128:131], a[108:111], v[20:23]
    ds_read_b128 v[156:159], v1 offset:15360
    s_waitcnt lgkmcnt(6)
    v_mfma_f32_16x16x32_bf16 v[24:27], v[132:135], a[104:107], v[24:27]
    v_mfma_f32_16x16x32_bf16 v[28:31], v[132:135], a[108:111], v[28:31]
    buffer_load_dwordx4 a[132:135], v1, s[8:11], s54 offen offset:1024
    ds_read_b128 v[128:131], v1 offset:16384
    s_waitcnt lgkmcnt(6)
    v_mfma_f32_16x16x32_bf16 v[32:35], v[136:139], a[104:107], v[32:35]
    v_mfma_f32_16x16x32_bf16 v[36:39], v[136:139], a[108:111], v[36:39]
    ds_read_b128 v[132:135], v1 offset:17408
    s_waitcnt lgkmcnt(6)
    v_mfma_f32_16x16x32_bf16 v[40:43], v[140:143], a[104:107], v[40:43]
    v_mfma_f32_16x16x32_bf16 v[44:47], v[140:143], a[108:111], v[44:47]
    ds_read_b128 v[136:139], v1 offset:18432
    s_waitcnt lgkmcnt(6)
    v_mfma_f32_16x16x32_bf16 v[48:51], v[144:147], a[104:107], v[48:51]
    v_mfma_f32_16x16x32_bf16 v[52:55], v[144:147], a[108:111], v[52:55]
    buffer_load_dwordx4 a[136:139], v1, s[8:11], s54 offen offset:2048
    ds_read_b128 v[140:143], v1 offset:19456
    s_waitcnt lgkmcnt(6)
    v_mfma_f32_16x16x32_bf16 v[56:59], v[148:151], a[104:107], v[56:59]
    v_mfma_f32_16x16x32_bf16 v[60:63], v[148:151], a[108:111], v[60:63]
    ds_read_b128 v[144:147], v1 offset:20480
    s_waitcnt lgkmcnt(6)
    v_mfma_f32_16x16x32_bf16 v[64:67], v[152:155], a[104:107], v[64:67]
    v_mfma_f32_16x16x32_bf16 v[68:71], v[152:155], a[108:111], v[68:71]
    ds_read_b128 v[148:151], v1 offset:21504
    s_waitcnt lgkmcnt(6)
    v_mfma_f32_16x16x32_bf16 v[72:75], v[156:159], a[104:107], v[72:75]
    v_mfma_f32_16x16x32_bf16 v[76:79], v[156:159], a[108:111], v[76:79]
    buffer_load_dwordx4 a[140:143], v1, s[8:11], s54 offen offset:3072
    s_add_u32 s54, s54, 4096
    s_waitcnt vmcnt(22)
    ds_read_b128 v[152:155], v1 offset:22528
    s_waitcnt lgkmcnt(6)
    v_mfma_f32_16x16x32_bf16 v[16:19], v[128:131], a[112:115], v[16:19]
    v_mfma_f32_16x16x32_bf16 v[20:23], v[128:131], a[116:119], v[20:23]
    ds_read_b128 v[156:159], v1 offset:23552
    s_waitcnt lgkmcnt(6)
    v_mfma_f32_16x16x32_bf16 v[24:27], v[132:135], a[112:115], v[24:27]
    v_mfma_f32_16x16x32_bf16 v[28:31], v[132:135], a[116:119], v[28:31]
    ds_read_b128 v[128:131], v1 offset:24576
    s_waitcnt lgkmcnt(6)
    v_mfma_f32_16x16x32_bf16 v[32:35], v[136:139], a[112:115], v[32:35]
    v_mfma_f32_16x16x32_bf16 v[36:39], v[136:139], a[116:119], v[36:39]
    buffer_load_dwordx4 a[144:147], v1, s[8:11], s54 offen offset:0
    ds_read_b128 v[132:135], v1 offset:25600
    s_waitcnt lgkmcnt(6)
    v_mfma_f32_16x16x32_bf16 v[40:43], v[140:143], a[112:115], v[40:43]
    v_mfma_f32_16x16x32_bf16 v[44:47], v[140:143], a[116:119], v[44:47]
    ds_read_b128 v[136:139], v1 offset:26624
    s_waitcnt lgkmcnt(6)
    v_mfma_f32_16x16x32_bf16 v[48:51], v[144:147], a[112:115], v[48:51]
    v_mfma_f32_16x16x32_bf16 v[52:55], v[144:147], a[116:119], v[52:55]
    ds_read_b128 v[140:143], v1 offset:27648
    s_waitcnt lgkmcnt(6)
    v_mfma_f32_16x16x32_bf16 v[56:59], v[148:151], a[112:115], v[56:59]
    v_mfma_f32_16x16x32_bf16 v[60:63], v[148:151], a[116:119], v[60:63]
    buffer_load_dwordx4 a[148:151], v1, s[8:11], s54 offen offset:1024
    ds_read_b128 v[144:147], v1 offset:28672
    s_waitcnt lgkmcnt(6)
    v_mfma_f32_16x16x32_bf16 v[64:67], v[152:155], a[112:115], v[64:67]
    v_mfma_f32_16x16x32_bf16 v[68:71], v[152:155], a[116:119], v[68:71]
    ds_read_b128 v[148:151], v1 offset:29696
    s_waitcnt lgkmcnt(6)
    v_mfma_f32_16x16x32_bf16 v[72:75], v[156:159], a[112:115], v[72:75]
    v_mfma_f32_16x16x32_bf16 v[76:79], v[156:159], a[116:119], v[76:79]
    s_waitcnt vmcnt(14)
    ds_read_b128 v[152:155], v1 offset:30720
    s_waitcnt lgkmcnt(6)
    v_mfma_f32_16x16x32_bf16 v[16:19], v[128:131], a[120:123], v[16:19]
    v_mfma_f32_16x16x32_bf16 v[20:23], v[128:131], a[124:127], v[20:23]
    buffer_load_dwordx4 a[152:155], v1, s[8:11], s54 offen offset:2048
    ds_read_b128 v[156:159], v1 offset:31744
    s_waitcnt lgkmcnt(6)
    v_mfma_f32_16x16x32_bf16 v[24:27], v[132:135], a[120:123], v[24:27]
    v_mfma_f32_16x16x32_bf16 v[28:31], v[132:135], a[124:127], v[28:31]
    ds_read_b128 v[128:131], v1 offset:32768
    s_waitcnt lgkmcnt(6)
    v_mfma_f32_16x16x32_bf16 v[32:35], v[136:139], a[120:123], v[32:35]
    v_mfma_f32_16x16x32_bf16 v[36:39], v[136:139], a[124:127], v[36:39]
    ds_read_b128 v[132:135], v1 offset:33792
    s_waitcnt lgkmcnt(6)
    v_mfma_f32_16x16x32_bf16 v[40:43], v[140:143], a[120:123], v[40:43]
    v_mfma_f32_16x16x32_bf16 v[44:47], v[140:143], a[124:127], v[44:47]
    buffer_load_dwordx4 a[156:159], v1, s[8:11], s54 offen offset:3072
    s_add_u32 s54, s54, 4096
    ds_read_b128 v[136:139], v1 offset:34816
    s_waitcnt lgkmcnt(6)
    v_mfma_f32_16x16x32_bf16 v[48:51], v[144:147], a[120:123], v[48:51]
    v_mfma_f32_16x16x32_bf16 v[52:55], v[144:147], a[124:127], v[52:55]
    ds_read_b128 v[140:143], v1 offset:35840
    s_waitcnt lgkmcnt(6)
    v_mfma_f32_16x16x32_bf16 v[56:59], v[148:151], a[120:123], v[56:59]
    v_mfma_f32_16x16x32_bf16 v[60:63], v[148:151], a[124:127], v[60:63]
    ds_read_b128 v[144:147], v1 offset:36864
    s_waitcnt lgkmcnt(6)
    v_mfma_f32_16x16x32_bf16 v[64:67], v[152:155], a[120:123], v[64:67]
    v_mfma_f32_16x16x32_bf16 v[68:71], v[152:155], a[124:127], v[68:71]
    buffer_load_dwordx4 a[160:163], v1, s[8:11], s54 offen offset:0
    ds_read_b128 v[148:151], v1 offset:37888
    s_waitcnt lgkmcnt(6)
    v_mfma_f32_16x16x32_bf16 v[72:75], v[156:159], a[120:123], v[72:75]
    v_mfma_f32_16x16x32_bf16 v[76:79], v[156:159], a[124:127], v[76:79]
    v_mfma_f32_16x16x16_bf16 v[16:19], v[160:161], v[200:201], v[16:19]
    v_mfma_f32_16x16x16_bf16 v[20:23], v[160:161], v[202:203], v[20:23]
    v_mfma_f32_16x16x16_bf16 v[24:27], v[162:163], v[200:201], v[24:27]
    v_mfma_f32_16x16x16_bf16 v[28:31], v[162:163], v[202:203], v[28:31]
    v_mfma_f32_16x16x16_bf16 v[32:35], v[164:165], v[200:201], v[32:35]
    v_mfma_f32_16x16x16_bf16 v[36:39], v[164:165], v[202:203], v[36:39]
    v_mfma_f32_16x16x16_bf16 v[40:43], v[166:167], v[200:201], v[40:43]
    v_mfma_f32_16x16x16_bf16 v[44:47], v[166:167], v[202:203], v[44:47]
    v_mfma_f32_16x16x16_bf16 v[48:51], v[168:169], v[200:201], v[48:51]
    v_mfma_f32_16x16x16_bf16 v[52:55], v[168:169], v[202:203], v[52:55]
    v_mfma_f32_16x16x16_bf16 v[56:59], v[170:171], v[200:201], v[56:59]
    v_mfma_f32_16x16x16_bf16 v[60:63], v[170:171], v[202:203], v[60:63]
    v_mfma_f32_16x16x16_bf16 v[64:67], v[172:173], v[200:201], v[64:67]
    v_mfma_f32_16x16x16_bf16 v[68:71], v[172:173], v[202:203], v[68:71]
    v_mfma_f32_16x16x16_bf16 v[72:75], v[174:175], v[200:201], v[72:75]
    v_mfma_f32_16x16x16_bf16 v[76:79], v[174:175], v[202:203], v[76:79]
    ds_read_b128 v[152:155], v1 offset:38912
    s_waitcnt lgkmcnt(6)
    v_mfma_f32_16x16x32_bf16 v[80:83], v[128:131], a[0:3], 0
    v_mfma_f32_16x16x32_bf16 v[84:87], v[128:131], a[4:7], 0
    ds_read_b128 v[156:159], v1 offset:39936
    s_waitcnt lgkmcnt(6)
    v_mfma_f32_16x16x32_bf16 v[88:91], v[132:135], a[0:3], 0
    v_mfma_f32_16x16x32_bf16 v[92:95], v[132:135], a[4:7], 0
    buffer_load_dwordx4 a[164:167], v1, s[8:11], s54 offen offset:1024
    ds_read_b128 v[128:131], v1 offset:40960
    s_waitcnt lgkmcnt(6)
    v_mfma_f32_16x16x32_bf16 v[96:99], v[136:139], a[0:3], 0
    v_mfma_f32_16x16x32_bf16 v[100:103], v[136:139], a[4:7], 0
    ds_read_b128 v[132:135], v1 offset:41984
    s_waitcnt lgkmcnt(6)
    v_mfma_f32_16x16x32_bf16 v[104:107], v[140:143], a[0:3], 0
    v_mfma_f32_16x16x32_bf16 v[108:111], v[140:143], a[4:7], 0
    ds_read_b128 v[136:139], v1 offset:43008
    s_waitcnt lgkmcnt(6)
    v_mfma_f32_16x16x32_bf16 v[112:115], v[144:147], a[0:3], 0
    v_mfma_f32_16x16x32_bf16 v[116:119], v[144:147], a[4:7], 0
    v_max_f32 v16, 0, v16
    v_max_f32 v17, 0, v17
    buffer_load_dwordx4 a[168:171], v1, s[8:11], s54 offen offset:2048
    ds_read_b128 v[140:143], v1 offset:44032
    s_waitcnt lgkmcnt(6)
    v_mfma_f32_16x16x32_bf16 v[120:123], v[148:151], a[0:3], 0
    v_mfma_f32_16x16x32_bf16 v[124:127], v[148:151], a[4:7], 0
    v_max_f32 v18, 0, v18
    v_max_f32 v19, 0, v19
    ds_read_b128 v[144:147], v1 offset:45056
    s_waitcnt lgkmcnt(6)
    v_mfma_f32_16x16x32_bf16 v[80:83], v[152:155], a[8:11], v[80:83]
    v_mfma_f32_16x16x32_bf16 v[84:87], v[152:155], a[12:15], v[84:87]
    v_mul_f32 v16, v16, v24
    v_mul_f32 v17, v17, v25
    ds_read_b128 v[148:151], v1 offset:46080
    s_waitcnt lgkmcnt(6)
    v_mfma_f32_16x16x32_bf16 v[88:91], v[156:159], a[8:11], v[88:91]
    v_mfma_f32_16x16x32_bf16 v[92:95], v[156:159], a[12:15], v[92:95]
    v_mul_f32 v18, v18, v26
    v_mul_f32 v19, v19, v27
    buffer_load_dwordx4 a[172:175], v1, s[8:11], s54 offen offset:3072
    s_add_u32 s54, s54, 4096
    ds_read_b128 v[152:155], v1 offset:47104
    s_waitcnt lgkmcnt(6)
    v_mfma_f32_16x16x32_bf16 v[96:99], v[128:131], a[8:11], v[96:99]
    v_mfma_f32_16x16x32_bf16 v[100:103], v[128:131], a[12:15], v[100:103]
    v_cvt_pk_bf16_f32 v24, v16, v17
    v_cvt_pk_bf16_f32 v25, v18, v19
    ds_read_b128 v[156:159], v1 offset:48128
    s_waitcnt lgkmcnt(6)
    v_mfma_f32_16x16x32_bf16 v[104:107], v[132:135], a[8:11], v[104:107]
    v_mfma_f32_16x16x32_bf16 v[108:111], v[132:135], a[12:15], v[108:111]
    v_max_f32 v20, 0, v20
    v_max_f32 v21, 0, v21
    ds_read_b128 v[128:131], v1 offset:49152
    s_waitcnt lgkmcnt(6)
    v_mfma_f32_16x16x32_bf16 v[112:115], v[136:139], a[8:11], v[112:115]
    v_mfma_f32_16x16x32_bf16 v[116:119], v[136:139], a[12:15], v[116:119]
    v_max_f32 v22, 0, v22
    v_max_f32 v23, 0, v23
    buffer_load_dwordx4 a[176:179], v1, s[8:11], s54 offen offset:0
    ds_read_b128 v[132:135], v1 offset:50176
    s_waitcnt lgkmcnt(6)
    v_mfma_f32_16x16x32_bf16 v[120:123], v[140:143], a[8:11], v[120:123]
    v_mfma_f32_16x16x32_bf16 v[124:127], v[140:143], a[12:15], v[124:127]
    v_mul_f32 v20, v20, v28
    v_mul_f32 v21, v21, v29
    ds_read_b128 v[136:139], v1 offset:51200
    s_waitcnt lgkmcnt(6)
    v_mfma_f32_16x16x32_bf16 v[80:83], v[144:147], a[16:19], v[80:83]
    v_mfma_f32_16x16x32_bf16 v[84:87], v[144:147], a[20:23], v[84:87]
    v_mul_f32 v22, v22, v30
    v_mul_f32 v23, v23, v31
    ds_read_b128 v[140:143], v1 offset:52224
    s_waitcnt lgkmcnt(6)
    v_mfma_f32_16x16x32_bf16 v[88:91], v[148:151], a[16:19], v[88:91]
    v_mfma_f32_16x16x32_bf16 v[92:95], v[148:151], a[20:23], v[92:95]
    v_cvt_pk_bf16_f32 v28, v20, v21
    v_cvt_pk_bf16_f32 v29, v22, v23
    buffer_load_dwordx4 a[180:183], v1, s[8:11], s54 offen offset:1024
    ds_read_b128 v[144:147], v1 offset:53248
    s_waitcnt lgkmcnt(6)
    v_mfma_f32_16x16x32_bf16 v[96:99], v[152:155], a[16:19], v[96:99]
    v_mfma_f32_16x16x32_bf16 v[100:103], v[152:155], a[20:23], v[100:103]
    v_max_f32 v32, 0, v32
    v_max_f32 v33, 0, v33
    ds_read_b128 v[148:151], v1 offset:54272
    s_waitcnt lgkmcnt(6)
    v_mfma_f32_16x16x32_bf16 v[104:107], v[156:159], a[16:19], v[104:107]
    v_mfma_f32_16x16x32_bf16 v[108:111], v[156:159], a[20:23], v[108:111]
    v_max_f32 v34, 0, v34
    v_max_f32 v35, 0, v35
    ds_read_b128 v[152:155], v1 offset:55296
    s_waitcnt lgkmcnt(6)
    v_mfma_f32_16x16x32_bf16 v[112:115], v[128:131], a[16:19], v[112:115]
    v_mfma_f32_16x16x32_bf16 v[116:119], v[128:131], a[20:23], v[116:119]
    v_mul_f32 v32, v32, v40
    v_mul_f32 v33, v33, v41
    buffer_load_dwordx4 a[184:187], v1, s[8:11], s54 offen offset:2048
    ds_read_b128 v[156:159], v1 offset:56320
    s_waitcnt lgkmcnt(6)
    v_mfma_f32_16x16x32_bf16 v[120:123], v[132:135], a[16:19], v[120:123]
    v_mfma_f32_16x16x32_bf16 v[124:127], v[132:135], a[20:23], v[124:127]
    v_mul_f32 v34, v34, v42
    v_mul_f32 v35, v35, v43
    ds_read_b128 v[128:131], v1 offset:57344
    s_waitcnt lgkmcnt(6)
    v_mfma_f32_16x16x32_bf16 v[80:83], v[136:139], a[24:27], v[80:83]
    v_mfma_f32_16x16x32_bf16 v[84:87], v[136:139], a[28:31], v[84:87]
    v_cvt_pk_bf16_f32 v26, v32, v33
    v_cvt_pk_bf16_f32 v27, v34, v35
    ds_read_b128 v[132:135], v1 offset:58368
    s_waitcnt lgkmcnt(6)
    v_mfma_f32_16x16x32_bf16 v[88:91], v[140:143], a[24:27], v[88:91]
    v_mfma_f32_16x16x32_bf16 v[92:95], v[140:143], a[28:31], v[92:95]
    buffer_store_dwordx4 v[24:27], v1, s[8:11], s35 offen offset:0 sc1
    v_max_f32 v36, 0, v36
    buffer_load_dwordx4 a[188:191], v1, s[8:11], s54 offen offset:3072
    s_add_u32 s54, s54, 4096
    ds_read_b128 v[136:139], v1 offset:59392
    s_waitcnt lgkmcnt(6)
    v_mfma_f32_16x16x32_bf16 v[96:99], v[144:147], a[24:27], v[96:99]
    v_mfma_f32_16x16x32_bf16 v[100:103], v[144:147], a[28:31], v[100:103]
    v_max_f32 v37, 0, v37
    v_max_f32 v38, 0, v38
    ds_read_b128 v[140:143], v1 offset:60416
    s_waitcnt lgkmcnt(6)
    v_mfma_f32_16x16x32_bf16 v[104:107], v[148:151], a[24:27], v[104:107]
    v_mfma_f32_16x16x32_bf16 v[108:111], v[148:151], a[28:31], v[108:111]
    v_max_f32 v39, 0, v39
    v_mul_f32 v36, v36, v44
    ds_read_b128 v[144:147], v1 offset:61440
    s_waitcnt lgkmcnt(6)
    v_mfma_f32_16x16x32_bf16 v[112:115], v[152:155], a[24:27], v[112:115]
    v_mfma_f32_16x16x32_bf16 v[116:119], v[152:155], a[28:31], v[116:119]
    v_mul_f32 v37, v37, v45
    v_mul_f32 v38, v38, v46
    buffer_load_dwordx4 a[192:195], v1, s[8:11], s54 offen offset:0
    ds_read_b128 v[148:151], v1 offset:62464
    s_waitcnt lgkmcnt(6)
    v_mfma_f32_16x16x32_bf16 v[120:123], v[156:159], a[24:27], v[120:123]
    v_mfma_f32_16x16x32_bf16 v[124:127], v[156:159], a[28:31], v[124:127]
    v_mul_f32 v39, v39, v47
    v_cvt_pk_bf16_f32 v30, v36, v37
    ds_read_b128 v[152:155], v1 offset:63488
    s_waitcnt lgkmcnt(6)
    v_mfma_f32_16x16x32_bf16 v[80:83], v[128:131], a[32:35], v[80:83]
    v_mfma_f32_16x16x32_bf16 v[84:87], v[128:131], a[36:39], v[84:87]
    v_cvt_pk_bf16_f32 v31, v38, v39
    buffer_store_dwordx4 v[28:31], v1, s[8:11], s35 offen offset:1024 sc1
    ds_read_b128 v[156:159], v1 offset:64512
    s_waitcnt lgkmcnt(6)
    v_mfma_f32_16x16x32_bf16 v[88:91], v[132:135], a[32:35], v[88:91]
    v_mfma_f32_16x16x32_bf16 v[92:95], v[132:135], a[36:39], v[92:95]
    s_add_u32 s35, s35, 4096
    v_max_f32 v48, 0, v48
    buffer_load_dwordx4 a[196:199], v1, s[8:11], s54 offen offset:1024
    s_barrier
    ds_read_b128 v[128:131], v14 offset:0
    s_waitcnt lgkmcnt(6)
    v_mfma_f32_16x16x32_bf16 v[96:99], v[136:139], a[32:35], v[96:99]
    v_mfma_f32_16x16x32_bf16 v[100:103], v[136:139], a[36:39], v[100:103]
    v_max_f32 v49, 0, v49
    v_max_f32 v50, 0, v50
    ds_read_b128 v[132:135], v14 offset:1024
    s_waitcnt lgkmcnt(6)
    v_mfma_f32_16x16x32_bf16 v[104:107], v[140:143], a[32:35], v[104:107]
    v_mfma_f32_16x16x32_bf16 v[108:111], v[140:143], a[36:39], v[108:111]
    v_max_f32 v51, 0, v51
    v_mul_f32 v48, v48, v56
    ds_read_b128 v[136:139], v14 offset:2048
    s_waitcnt lgkmcnt(6)
    v_mfma_f32_16x16x32_bf16 v[112:115], v[144:147], a[32:35], v[112:115]
    v_mfma_f32_16x16x32_bf16 v[116:119], v[144:147], a[36:39], v[116:119]
    v_mul_f32 v49, v49, v57
    v_mul_f32 v50, v50, v58
    buffer_load_dwordx4 a[200:203], v1, s[8:11], s54 offen offset:2048
    ds_read_b128 v[140:143], v14 offset:3072
    s_waitcnt lgkmcnt(6)
    v_mfma_f32_16x16x32_bf16 v[120:123], v[148:151], a[32:35], v[120:123]
    v_mfma_f32_16x16x32_bf16 v[124:127], v[148:151], a[36:39], v[124:127]
    v_mul_f32 v51, v51, v59
    v_cvt_pk_bf16_f32 v56, v48, v49
    ds_read_b128 v[144:147], v14 offset:4096
    s_waitcnt lgkmcnt(6)
    v_mfma_f32_16x16x32_bf16 v[80:83], v[152:155], a[40:43], v[80:83]
    v_mfma_f32_16x16x32_bf16 v[84:87], v[152:155], a[44:47], v[84:87]
    v_cvt_pk_bf16_f32 v57, v50, v51
    v_max_f32 v52, 0, v52
    ds_read_b128 v[148:151], v14 offset:5120
    s_waitcnt lgkmcnt(6)
    v_mfma_f32_16x16x32_bf16 v[88:91], v[156:159], a[40:43], v[88:91]
    v_mfma_f32_16x16x32_bf16 v[92:95], v[156:159], a[44:47], v[92:95]
    v_max_f32 v53, 0, v53
    v_max_f32 v54, 0, v54
    buffer_load_dwordx4 a[204:207], v1, s[8:11], s54 offen offset:3072
    s_add_u32 s54, s54, 4096
    ds_read_b128 v[152:155], v14 offset:6144
    s_waitcnt lgkmcnt(6)
    v_mfma_f32_16x16x32_bf16 v[96:99], v[128:131], a[40:43], v[96:99]
    v_mfma_f32_16x16x32_bf16 v[100:103], v[128:131], a[44:47], v[100:103]
    v_max_f32 v55, 0, v55
    v_mul_f32 v52, v52, v60
    ds_read_b128 v[156:159], v14 offset:7168
    s_waitcnt lgkmcnt(6)
    v_mfma_f32_16x16x32_bf16 v[104:107], v[132:135], a[40:43], v[104:107]
    v_mfma_f32_16x16x32_bf16 v[108:111], v[132:135], a[44:47], v[108:111]
    v_mul_f32 v53, v53, v61
    v_mul_f32 v54, v54, v62
    ds_read_b128 v[128:131], v14 offset:8192
    s_waitcnt lgkmcnt(6)
    v_mfma_f32_16x16x32_bf16 v[112:115], v[136:139], a[40:43], v[112:115]
    v_mfma_f32_16x16x32_bf16 v[116:119], v[136:139], a[44:47], v[116:119]
    v_mul_f32 v55, v55, v63
    v_cvt_pk_bf16_f32 v60, v52, v53
    buffer_load_dwordx4 a[208:211], v1, s[8:11], s54 offen offset:0
    ds_read_b128 v[132:135], v14 offset:9216
    s_waitcnt lgkmcnt(6)
    v_mfma_f32_16x16x32_bf16 v[120:123], v[140:143], a[40:43], v[120:123]
    v_mfma_f32_16x16x32_bf16 v[124:127], v[140:143], a[44:47], v[124:127]
    v_cvt_pk_bf16_f32 v61, v54, v55
    v_max_f32 v64, 0, v64
    ds_read_b128 v[136:139], v14 offset:10240
    s_waitcnt lgkmcnt(6)
    v_mfma_f32_16x16x32_bf16 v[80:83], v[144:147], a[48:51], v[80:83]
    v_mfma_f32_16x16x32_bf16 v[84:87], v[144:147], a[52:55], v[84:87]
    v_max_f32 v65, 0, v65
    v_max_f32 v66, 0, v66
    ds_read_b128 v[140:143], v14 offset:11264
    s_waitcnt lgkmcnt(6)
    v_mfma_f32_16x16x32_bf16 v[88:91], v[148:151], a[48:51], v[88:91]
    v_mfma_f32_16x16x32_bf16 v[92:95], v[148:151], a[52:55], v[92:95]
    v_max_f32 v67, 0, v67
    v_mul_f32 v64, v64, v72
    buffer_load_dwordx4 a[212:215], v1, s[8:11], s54 offen offset:1024
    ds_read_b128 v[144:147], v14 offset:12288
    s_waitcnt lgkmcnt(6)
    v_mfma_f32_16x16x32_bf16 v[96:99], v[152:155], a[48:51], v[96:99]
    v_mfma_f32_16x16x32_bf16 v[100:103], v[152:155], a[52:55], v[100:103]
    v_mul_f32 v65, v65, v73
    v_mul_f32 v66, v66, v74
    ds_read_b128 v[148:151], v14 offset:13312
    s_waitcnt lgkmcnt(6)
    v_mfma_f32_16x16x32_bf16 v[104:107], v[156:159], a[48:51], v[104:107]
    v_mfma_f32_16x16x32_bf16 v[108:111], v[156:159], a[52:55], v[108:111]
    v_mul_f32 v67, v67, v75
    v_cvt_pk_bf16_f32 v58, v64, v65
    ds_read_b128 v[152:155], v14 offset:14336
    s_waitcnt lgkmcnt(6)
    v_mfma_f32_16x16x32_bf16 v[112:115], v[128:131], a[48:51], v[112:115]
    v_mfma_f32_16x16x32_bf16 v[116:119], v[128:131], a[52:55], v[116:119]
    v_cvt_pk_bf16_f32 v59, v66, v67
    buffer_store_dwordx4 v[56:59], v1, s[8:11], s35 offen offset:0 sc1
    buffer_load_dwordx4 a[216:219], v1, s[8:11], s54 offen offset:2048
    ds_read_b128 v[156:159], v14 offset:15360
    s_waitcnt lgkmcnt(6)
    v_mfma_f32_16x16x32_bf16 v[120:123], v[132:135], a[48:51], v[120:123]
    v_mfma_f32_16x16x32_bf16 v[124:127], v[132:135], a[52:55], v[124:127]
    v_max_f32 v68, 0, v68
    v_max_f32 v69, 0, v69
    ds_read_b128 v[128:131], v14 offset:16384
    s_waitcnt lgkmcnt(6)
    v_mfma_f32_16x16x32_bf16 v[80:83], v[136:139], a[56:59], v[80:83]
    v_mfma_f32_16x16x32_bf16 v[84:87], v[136:139], a[60:63], v[84:87]
    v_max_f32 v70, 0, v70
    v_max_f32 v71, 0, v71
    ds_read_b128 v[132:135], v14 offset:17408
    s_waitcnt lgkmcnt(6)
    v_mfma_f32_16x16x32_bf16 v[88:91], v[140:143], a[56:59], v[88:91]
    v_mfma_f32_16x16x32_bf16 v[92:95], v[140:143], a[60:63], v[92:95]
    v_mul_f32 v68, v68, v76
    v_mul_f32 v69, v69, v77
    buffer_load_dwordx4 a[220:223], v1, s[8:11], s54 offen offset:3072
    s_add_u32 s54, s54, 4096
    ds_read_b128 v[136:139], v14 offset:18432
    s_waitcnt lgkmcnt(6)
    v_mfma_f32_16x16x32_bf16 v[96:99], v[144:147], a[56:59], v[96:99]
    v_mfma_f32_16x16x32_bf16 v[100:103], v[144:147], a[60:63], v[100:103]
    v_mul_f32 v70, v70, v78
    v_mul_f32 v71, v71, v79
    ds_read_b128 v[140:143], v14 offset:19456
    s_waitcnt lgkmcnt(6)
    v_mfma_f32_16x16x32_bf16 v[104:107], v[148:151], a[56:59], v[104:107]
    v_mfma_f32_16x16x32_bf16 v[108:111], v[148:151], a[60:63], v[108:111]
    v_cvt_pk_bf16_f32 v62, v68, v69
    v_cvt_pk_bf16_f32 v63, v70, v71
    ds_read_b128 v[144:147], v14 offset:20480
    s_waitcnt lgkmcnt(6)
    v_mfma_f32_16x16x32_bf16 v[112:115], v[152:155], a[56:59], v[112:115]
    v_mfma_f32_16x16x32_bf16 v[116:119], v[152:155], a[60:63], v[116:119]
    buffer_store_dwordx4 v[60:63], v1, s[8:11], s35 offen offset:1024 sc1
    s_add_u32 s35, s35, 4096
    buffer_load_dwordx4 a[224:227], v1, s[8:11], s54 offen offset:0
    ds_read_b128 v[148:151], v14 offset:21504
    s_waitcnt lgkmcnt(6)
    v_mfma_f32_16x16x32_bf16 v[120:123], v[156:159], a[56:59], v[120:123]
    v_mfma_f32_16x16x32_bf16 v[124:127], v[156:159], a[60:63], v[124:127]
    ds_read_b128 v[152:155], v14 offset:22528
    s_waitcnt lgkmcnt(6)
    v_mfma_f32_16x16x32_bf16 v[80:83], v[128:131], a[64:67], v[80:83]
    v_mfma_f32_16x16x32_bf16 v[84:87], v[128:131], a[68:71], v[84:87]
    ds_read_b128 v[156:159], v14 offset:23552
    s_waitcnt lgkmcnt(6)
    v_mfma_f32_16x16x32_bf16 v[88:91], v[132:135], a[64:67], v[88:91]
    v_mfma_f32_16x16x32_bf16 v[92:95], v[132:135], a[68:71], v[92:95]
    buffer_load_dwordx4 a[228:231], v1, s[8:11], s54 offen offset:1024
    ds_read_b128 v[128:131], v14 offset:24576
    s_waitcnt lgkmcnt(6)
    v_mfma_f32_16x16x32_bf16 v[96:99], v[136:139], a[64:67], v[96:99]
    v_mfma_f32_16x16x32_bf16 v[100:103], v[136:139], a[68:71], v[100:103]
    ds_read_b128 v[132:135], v14 offset:25600
    s_waitcnt lgkmcnt(6)
    v_mfma_f32_16x16x32_bf16 v[104:107], v[140:143], a[64:67], v[104:107]
    v_mfma_f32_16x16x32_bf16 v[108:111], v[140:143], a[68:71], v[108:111]
    ds_read_b128 v[136:139], v14 offset:26624
    s_waitcnt lgkmcnt(6)
    v_mfma_f32_16x16x32_bf16 v[112:115], v[144:147], a[64:67], v[112:115]
    v_mfma_f32_16x16x32_bf16 v[116:119], v[144:147], a[68:71], v[116:119]
    buffer_load_dwordx4 a[232:235], v1, s[8:11], s54 offen offset:2048
    ds_read_b128 v[140:143], v14 offset:27648
    s_waitcnt lgkmcnt(6)
    v_mfma_f32_16x16x32_bf16 v[120:123], v[148:151], a[64:67], v[120:123]
    v_mfma_f32_16x16x32_bf16 v[124:127], v[148:151], a[68:71], v[124:127]
    ds_read_b128 v[144:147], v14 offset:28672
    s_waitcnt lgkmcnt(6)
    v_mfma_f32_16x16x32_bf16 v[80:83], v[152:155], a[72:75], v[80:83]
    v_mfma_f32_16x16x32_bf16 v[84:87], v[152:155], a[76:79], v[84:87]
    ds_read_b128 v[148:151], v14 offset:29696
    s_waitcnt lgkmcnt(6)
    v_mfma_f32_16x16x32_bf16 v[88:91], v[156:159], a[72:75], v[88:91]
    v_mfma_f32_16x16x32_bf16 v[92:95], v[156:159], a[76:79], v[92:95]
    buffer_load_dwordx4 a[236:239], v1, s[8:11], s54 offen offset:3072
    s_add_u32 s54, s54, 4096
    ds_read_b128 v[152:155], v14 offset:30720
    s_waitcnt lgkmcnt(6)
    v_mfma_f32_16x16x32_bf16 v[96:99], v[128:131], a[72:75], v[96:99]
    v_mfma_f32_16x16x32_bf16 v[100:103], v[128:131], a[76:79], v[100:103]
    ds_read_b128 v[156:159], v14 offset:31744
    s_waitcnt lgkmcnt(6)
    v_mfma_f32_16x16x32_bf16 v[104:107], v[132:135], a[72:75], v[104:107]
    v_mfma_f32_16x16x32_bf16 v[108:111], v[132:135], a[76:79], v[108:111]
    s_waitcnt vmcnt(32)
    s_barrier
    ds_read_b128 v[128:131], v14 offset:32768
    s_waitcnt lgkmcnt(6)
    v_mfma_f32_16x16x32_bf16 v[112:115], v[136:139], a[72:75], v[112:115]
    v_mfma_f32_16x16x32_bf16 v[116:119], v[136:139], a[76:79], v[116:119]
    buffer_load_dwordx4 a[240:243], v1, s[8:11], s54 offen offset:0
    ds_read_b128 v[132:135], v14 offset:33792
    s_waitcnt lgkmcnt(6)
    v_mfma_f32_16x16x32_bf16 v[120:123], v[140:143], a[72:75], v[120:123]
    v_mfma_f32_16x16x32_bf16 v[124:127], v[140:143], a[76:79], v[124:127]
    ds_read_b128 v[136:139], v14 offset:34816
    s_waitcnt lgkmcnt(6)
    v_mfma_f32_16x16x32_bf16 v[80:83], v[144:147], a[80:83], v[80:83]
    v_mfma_f32_16x16x32_bf16 v[84:87], v[144:147], a[84:87], v[84:87]
    ds_read_b128 v[140:143], v14 offset:35840
    s_waitcnt lgkmcnt(6)
    v_mfma_f32_16x16x32_bf16 v[88:91], v[148:151], a[80:83], v[88:91]
    v_mfma_f32_16x16x32_bf16 v[92:95], v[148:151], a[84:87], v[92:95]
    buffer_load_dwordx4 a[244:247], v1, s[8:11], s54 offen offset:1024
    ds_read_b128 v[144:147], v14 offset:36864
    s_waitcnt lgkmcnt(6)
    v_mfma_f32_16x16x32_bf16 v[96:99], v[152:155], a[80:83], v[96:99]
    v_mfma_f32_16x16x32_bf16 v[100:103], v[152:155], a[84:87], v[100:103]
    ds_read_b128 v[148:151], v14 offset:37888
    s_waitcnt lgkmcnt(6)
    v_mfma_f32_16x16x32_bf16 v[104:107], v[156:159], a[80:83], v[104:107]
    v_mfma_f32_16x16x32_bf16 v[108:111], v[156:159], a[84:87], v[108:111]
    ds_read_b128 v[152:155], v14 offset:38912
    s_waitcnt lgkmcnt(6)
    v_mfma_f32_16x16x32_bf16 v[112:115], v[128:131], a[80:83], v[112:115]
    v_mfma_f32_16x16x32_bf16 v[116:119], v[128:131], a[84:87], v[116:119]
    buffer_load_dwordx4 a[248:251], v1, s[8:11], s54 offen offset:2048
    ds_read_b128 v[156:159], v14 offset:39936
    s_waitcnt lgkmcnt(6)
    v_mfma_f32_16x16x32_bf16 v[120:123], v[132:135], a[80:83], v[120:123]
    v_mfma_f32_16x16x32_bf16 v[124:127], v[132:135], a[84:87], v[124:127]
    ds_read_b128 v[128:131], v14 offset:40960
    s_waitcnt lgkmcnt(6)
    v_mfma_f32_16x16x32_bf16 v[80:83], v[136:139], a[88:91], v[80:83]
    v_mfma_f32_16x16x32_bf16 v[84:87], v[136:139], a[92:95], v[84:87]
    ds_read_b128 v[132:135], v14 offset:41984
    s_waitcnt lgkmcnt(6)
    v_mfma_f32_16x16x32_bf16 v[88:91], v[140:143], a[88:91], v[88:91]
    v_mfma_f32_16x16x32_bf16 v[92:95], v[140:143], a[92:95], v[92:95]
    buffer_load_dwordx4 a[252:255], v1, s[8:11], s54 offen offset:3072
    s_add_u32 s54, s54, 4096
    ds_read_b128 v[136:139], v14 offset:43008
    s_waitcnt lgkmcnt(6)
    v_mfma_f32_16x16x32_bf16 v[96:99], v[144:147], a[88:91], v[96:99]
    v_mfma_f32_16x16x32_bf16 v[100:103], v[144:147], a[92:95], v[100:103]
    ds_read_b128 v[140:143], v14 offset:44032
    s_waitcnt lgkmcnt(6)
    v_mfma_f32_16x16x32_bf16 v[104:107], v[148:151], a[88:91], v[104:107]
    v_mfma_f32_16x16x32_bf16 v[108:111], v[148:151], a[92:95], v[108:111]
    ds_read_b128 v[144:147], v14 offset:45056
    s_waitcnt lgkmcnt(6)
    v_mfma_f32_16x16x32_bf16 v[112:115], v[152:155], a[88:91], v[112:115]
    v_mfma_f32_16x16x32_bf16 v[116:119], v[152:155], a[92:95], v[116:119]
    buffer_load_dwordx4 v[212:215], v1, s[8:11], s54 offen offset:0
    ds_read_b128 v[148:151], v14 offset:46080
    s_waitcnt lgkmcnt(6)
    v_mfma_f32_16x16x32_bf16 v[120:123], v[156:159], a[88:91], v[120:123]
    v_mfma_f32_16x16x32_bf16 v[124:127], v[156:159], a[92:95], v[124:127]
    ds_read_b128 v[152:155], v14 offset:47104
    s_waitcnt lgkmcnt(6)
    v_mfma_f32_16x16x32_bf16 v[80:83], v[128:131], a[96:99], v[80:83]
    v_mfma_f32_16x16x32_bf16 v[84:87], v[128:131], a[100:103], v[84:87]
    ds_read_b128 v[156:159], v14 offset:48128
    s_waitcnt lgkmcnt(6)
    v_mfma_f32_16x16x32_bf16 v[88:91], v[132:135], a[96:99], v[88:91]
    v_mfma_f32_16x16x32_bf16 v[92:95], v[132:135], a[100:103], v[92:95]
    buffer_load_dwordx4 v[216:219], v1, s[8:11], s54 offen offset:1024
    ds_read_b128 v[128:131], v14 offset:49152
    s_waitcnt lgkmcnt(6)
    v_mfma_f32_16x16x32_bf16 v[96:99], v[136:139], a[96:99], v[96:99]
    v_mfma_f32_16x16x32_bf16 v[100:103], v[136:139], a[100:103], v[100:103]
    ds_read_b128 v[132:135], v14 offset:50176
    s_waitcnt lgkmcnt(6)
    v_mfma_f32_16x16x32_bf16 v[104:107], v[140:143], a[96:99], v[104:107]
    v_mfma_f32_16x16x32_bf16 v[108:111], v[140:143], a[100:103], v[108:111]
    ds_read_b128 v[136:139], v14 offset:51200
    s_waitcnt lgkmcnt(6)
    v_mfma_f32_16x16x32_bf16 v[112:115], v[144:147], a[96:99], v[112:115]
    v_mfma_f32_16x16x32_bf16 v[116:119], v[144:147], a[100:103], v[116:119]
    buffer_load_dwordx4 v[220:223], v1, s[8:11], s54 offen offset:2048
    ds_read_b128 v[140:143], v14 offset:52224
    s_waitcnt lgkmcnt(6)
    v_mfma_f32_16x16x32_bf16 v[120:123], v[148:151], a[96:99], v[120:123]
    v_mfma_f32_16x16x32_bf16 v[124:127], v[148:151], a[100:103], v[124:127]
    ds_read_b128 v[144:147], v14 offset:53248
    s_waitcnt lgkmcnt(6)
    v_mfma_f32_16x16x32_bf16 v[80:83], v[152:155], a[104:107], v[80:83]
    v_mfma_f32_16x16x32_bf16 v[84:87], v[152:155], a[108:111], v[84:87]
    ds_read_b128 v[148:151], v14 offset:54272
    s_waitcnt lgkmcnt(6)
    v_mfma_f32_16x16x32_bf16 v[88:91], v[156:159], a[104:107], v[88:91]
    v_mfma_f32_16x16x32_bf16 v[92:95], v[156:159], a[108:111], v[92:95]
    buffer_load_dwordx4 v[224:227], v1, s[8:11], s54 offen offset:3072
    s_add_u32 s54, s54, 4096
    ds_read_b128 v[152:155], v14 offset:55296
    s_waitcnt lgkmcnt(6)
    v_mfma_f32_16x16x32_bf16 v[96:99], v[128:131], a[104:107], v[96:99]
    v_mfma_f32_16x16x32_bf16 v[100:103], v[128:131], a[108:111], v[100:103]
    ds_read_b128 v[156:159], v14 offset:56320
    s_waitcnt lgkmcnt(6)
    v_mfma_f32_16x16x32_bf16 v[104:107], v[132:135], a[104:107], v[104:107]
    v_mfma_f32_16x16x32_bf16 v[108:111], v[132:135], a[108:111], v[108:111]
    ds_read_b128 v[128:131], v14 offset:57344
    s_waitcnt lgkmcnt(6)
    v_mfma_f32_16x16x32_bf16 v[112:115], v[136:139], a[104:107], v[112:115]
    v_mfma_f32_16x16x32_bf16 v[116:119], v[136:139], a[108:111], v[116:119]
    buffer_load_dwordx4 v[228:231], v1, s[8:11], s54 offen offset:0
    ds_read_b128 v[132:135], v14 offset:58368
    s_waitcnt lgkmcnt(6)
    v_mfma_f32_16x16x32_bf16 v[120:123], v[140:143], a[104:107], v[120:123]
    v_mfma_f32_16x16x32_bf16 v[124:127], v[140:143], a[108:111], v[124:127]
    ds_read_b128 v[136:139], v14 offset:59392
    s_waitcnt lgkmcnt(6)
    v_mfma_f32_16x16x32_bf16 v[80:83], v[144:147], a[112:115], v[80:83]
    v_mfma_f32_16x16x32_bf16 v[84:87], v[144:147], a[116:119], v[84:87]
    ds_read_b128 v[140:143], v14 offset:60416
    s_waitcnt lgkmcnt(6)
    v_mfma_f32_16x16x32_bf16 v[88:91], v[148:151], a[112:115], v[88:91]
    v_mfma_f32_16x16x32_bf16 v[92:95], v[148:151], a[116:119], v[92:95]
    buffer_load_dwordx4 v[232:235], v1, s[8:11], s54 offen offset:1024
    ds_read_b128 v[144:147], v14 offset:61440
    s_waitcnt lgkmcnt(6)
    v_mfma_f32_16x16x32_bf16 v[96:99], v[152:155], a[112:115], v[96:99]
    v_mfma_f32_16x16x32_bf16 v[100:103], v[152:155], a[116:119], v[100:103]
    ds_read_b128 v[148:151], v14 offset:62464
    s_waitcnt lgkmcnt(6)
    v_mfma_f32_16x16x32_bf16 v[104:107], v[156:159], a[112:115], v[104:107]
    v_mfma_f32_16x16x32_bf16 v[108:111], v[156:159], a[116:119], v[108:111]
    ds_read_b128 v[152:155], v14 offset:63488
    s_waitcnt lgkmcnt(6)
    v_mfma_f32_16x16x32_bf16 v[112:115], v[128:131], a[112:115], v[112:115]
    v_mfma_f32_16x16x32_bf16 v[116:119], v[128:131], a[116:119], v[116:119]
    buffer_load_dwordx4 v[236:239], v1, s[8:11], s54 offen offset:2048
    ds_read_b128 v[156:159], v14 offset:64512
    s_waitcnt lgkmcnt(6)
    v_mfma_f32_16x16x32_bf16 v[120:123], v[132:135], a[112:115], v[120:123]
    v_mfma_f32_16x16x32_bf16 v[124:127], v[132:135], a[116:119], v[124:127]
    s_waitcnt lgkmcnt(5)
    v_mfma_f32_16x16x32_bf16 v[80:83], v[136:139], a[120:123], v[80:83]
    v_mfma_f32_16x16x32_bf16 v[84:87], v[136:139], a[124:127], v[84:87]
    s_waitcnt lgkmcnt(4)
    v_mfma_f32_16x16x32_bf16 v[88:91], v[140:143], a[120:123], v[88:91]
    v_mfma_f32_16x16x32_bf16 v[92:95], v[140:143], a[124:127], v[92:95]
    buffer_load_dwordx4 v[240:243], v1, s[8:11], s54 offen offset:3072
    s_add_u32 s54, s54, 4096
    s_waitcnt lgkmcnt(3)
    v_mfma_f32_16x16x32_bf16 v[96:99], v[144:147], a[120:123], v[96:99]
    v_mfma_f32_16x16x32_bf16 v[100:103], v[144:147], a[124:127], v[100:103]
    s_waitcnt lgkmcnt(2)
    v_mfma_f32_16x16x32_bf16 v[104:107], v[148:151], a[120:123], v[104:107]
    v_mfma_f32_16x16x32_bf16 v[108:111], v[148:151], a[124:127], v[108:111]
    s_waitcnt lgkmcnt(1)
    v_mfma_f32_16x16x32_bf16 v[112:115], v[152:155], a[120:123], v[112:115]
    v_mfma_f32_16x16x32_bf16 v[116:119], v[152:155], a[124:127], v[116:119]
    s_waitcnt lgkmcnt(0)
    v_mfma_f32_16x16x32_bf16 v[120:123], v[156:159], a[120:123], v[120:123]
    v_mfma_f32_16x16x32_bf16 v[124:127], v[156:159], a[124:127], v[124:127]
    v_mfma_f32_16x16x16_bf16 v[80:83], v[176:177], v[200:201], v[80:83]
    v_mfma_f32_16x16x16_bf16 v[84:87], v[176:177], v[202:203], v[84:87]
    v_mfma_f32_16x16x16_bf16 v[88:91], v[178:179], v[200:201], v[88:91]
    v_mfma_f32_16x16x16_bf16 v[92:95], v[178:179], v[202:203], v[92:95]
    v_mfma_f32_16x16x16_bf16 v[96:99], v[180:181], v[200:201], v[96:99]
    v_mfma_f32_16x16x16_bf16 v[100:103], v[180:181], v[202:203], v[100:103]
    v_mfma_f32_16x16x16_bf16 v[104:107], v[182:183], v[200:201], v[104:107]
    v_mfma_f32_16x16x16_bf16 v[108:111], v[182:183], v[202:203], v[108:111]
    v_mfma_f32_16x16x16_bf16 v[112:115], v[184:185], v[200:201], v[112:115]
    v_mfma_f32_16x16x16_bf16 v[116:119], v[184:185], v[202:203], v[116:119]
    v_mfma_f32_16x16x16_bf16 v[120:123], v[186:187], v[200:201], v[120:123]
    v_mfma_f32_16x16x16_bf16 v[124:127], v[186:187], v[202:203], v[124:127]
    v_max_f32 v80, 0, v80
    v_max_f32 v81, 0, v81
    v_max_f32 v82, 0, v82
    v_max_f32 v83, 0, v83
    v_mul_f32 v80, v80, v88
    v_mul_f32 v81, v81, v89
    v_mul_f32 v82, v82, v90
    v_mul_f32 v83, v83, v91
    v_cvt_pk_bf16_f32 v88, v80, v81
    v_cvt_pk_bf16_f32 v89, v82, v83
    v_max_f32 v84, 0, v84
    v_max_f32 v85, 0, v85
    v_max_f32 v86, 0, v86
    v_max_f32 v87, 0, v87
    v_mul_f32 v84, v84, v92
    v_mul_f32 v85, v85, v93
    v_mul_f32 v86, v86, v94
    v_mul_f32 v87, v87, v95
    v_cvt_pk_bf16_f32 v92, v84, v85
    v_cvt_pk_bf16_f32 v93, v86, v87
    v_max_f32 v96, 0, v96
    v_max_f32 v97, 0, v97
    v_max_f32 v98, 0, v98
    v_max_f32 v99, 0, v99
    v_mul_f32 v96, v96, v104
    v_mul_f32 v97, v97, v105
    v_mul_f32 v98, v98, v106
    v_mul_f32 v99, v99, v107
    v_cvt_pk_bf16_f32 v90, v96, v97
    v_cvt_pk_bf16_f32 v91, v98, v99
    buffer_store_dwordx4 v[88:91], v1, s[8:11], s35 offen offset:0 sc1
    v_max_f32 v100, 0, v100
    v_max_f32 v101, 0, v101
    v_max_f32 v102, 0, v102
    v_max_f32 v103, 0, v103
    v_mul_f32 v100, v100, v108
    v_mul_f32 v101, v101, v109
    v_mul_f32 v102, v102, v110
    v_mul_f32 v103, v103, v111
    v_cvt_pk_bf16_f32 v94, v100, v101
    v_cvt_pk_bf16_f32 v95, v102, v103
    buffer_store_dwordx4 v[92:95], v1, s[8:11], s35 offen offset:1024 sc1
    s_add_u32 s35, s35, 4096
    v_max_f32 v112, 0, v112
    v_max_f32 v113, 0, v113
    v_max_f32 v114, 0, v114
    v_max_f32 v115, 0, v115
    v_mul_f32 v112, v112, v120
    v_mul_f32 v113, v113, v121
    v_mul_f32 v114, v114, v122
    v_mul_f32 v115, v115, v123
    v_cvt_pk_bf16_f32 v204, v112, v113
    v_cvt_pk_bf16_f32 v205, v114, v115
    v_max_f32 v116, 0, v116
    v_max_f32 v117, 0, v117
    v_max_f32 v118, 0, v118
    v_max_f32 v119, 0, v119
    v_mul_f32 v116, v116, v124
    v_mul_f32 v117, v117, v125
    v_mul_f32 v118, v118, v126
    v_mul_f32 v119, v119, v127
    v_cvt_pk_bf16_f32 v206, v116, v117
    v_cvt_pk_bf16_f32 v207, v118, v119
    buffer_store_dwordx4 v[204:207], v1, s[8:11], s36 offen sc1
    s_lshl_b32 s40, s22, 8
    s_lshl_b32 s41, s23, 2
    s_add_u32 s40, s40, s41
    s_add_u32 s40, s40, s26
    s_add_u32 s40, s40, 12288
    v_mov_b32 v6, 1
    v_mov_b32 v7, 0
    s_waitcnt vmcnt(0)
    s_barrier
    s_cmp_lg_u32 s3, 0
    s_cbranch_scc1 LSG_7
    s_mov_b64 exec, 1
    buffer_store_dword v6, v7, s[8:11], s40 offen sc1
    s_mov_b64 exec, -1
LSG_7:
    buffer_load_dwordx4 v[128:131], v1, s[8:11], s54 offen offset:0
    buffer_load_dwordx4 v[132:135], v1, s[8:11], s54 offen offset:1024
    buffer_load_dwordx4 v[136:139], v1, s[8:11], s54 offen offset:2048
    buffer_load_dwordx4 v[140:143], v1, s[8:11], s54 offen offset:3072
    s_add_u32 s54, s54, 4096
    buffer_load_dwordx4 v[144:147], v1, s[8:11], s54 offen offset:0
    buffer_load_dwordx4 v[148:151], v1, s[8:11], s54 offen offset:1024
    buffer_load_dwordx4 v[152:155], v1, s[8:11], s54 offen offset:2048
    buffer_load_dwordx4 v[156:159], v1, s[8:11], s54 offen offset:3072
    s_add_u32 s54, s54, 4096
    buffer_load_dwordx4 v[160:163], v1, s[8:11], s54 offen offset:0
    buffer_load_dwordx4 v[164:167], v1, s[8:11], s54 offen offset:1024
    buffer_load_dwordx4 v[168:171], v1, s[8:11], s54 offen offset:2048
    buffer_load_dwordx4 v[172:175], v1, s[8:11], s54 offen offset:3072
    s_add_u32 s54, s54, 4096
    buffer_load_dwordx4 v[176:179], v1, s[8:11], s54 offen offset:0
    buffer_load_dwordx4 v[180:183], v1, s[8:11], s54 offen offset:1024
    buffer_load_dwordx4 v[184:187], v1, s[8:11], s54 offen offset:2048
    buffer_load_dwordx4 v[188:191], v1, s[8:11], s54 offen offset:3072
    s_add_u32 s54, s54, 4096
    s_lshr_b32 s35, s20, 1
    s_lshl_b32 s49, s20, 2
    s_add_u32 s49, s49, s3
    s_lshl_b32 s49, s49, 10
    s_add_u32 s49, s49, s24
    s_add_u32 s49, s49, 0x1dc0000
    s_mul_i32 s48, s20, 56
    s_mul_i32 s34, s3, 14
    s_add_u32 s48, s48, s34
    s_lshl_b32 s48, s48, 12
    s_add_u32 s48, s48, s24
    s_add_u32 s48, s48, 0x1600000
    s_xor_b32 s34, s3, 1
    s_mul_i32 s34, s34, 12288
    s_add_u32 s34, s34, 98304
    v_add_u32 v208, s34, v1
    s_xor_b32 s34, s3, 2
    s_mul_i32 s34, s34, 12288
    s_add_u32 s34, s34, 102400
    v_add_u32 v209, s34, v1
    s_xor_b32 s34, s3, 3
    s_mul_i32 s34, s34, 12288
    s_add_u32 s34, s34, 106496
    v_add_u32 v210, s34, v1
    s_mul_i32 s34, s3, 12288
    s_add_u32 s34, s34, 98304
    v_add_u32 v211, s34, v1
    s_xor_b32 s34, s3, 0
    s_lshr_b32 s37, s34, 1
    s_lshl_b32 s37, s37, 10
    s_and_b32 s34, s34, 1
    s_lshl_b32 s34, s34, 3
    s_add_u32 s34, s34, s37
    v_add_u32 v200, s34, v1
    s_xor_b32 s34, s3, 1
    s_lshr_b32 s37, s34, 1
    s_lshl_b32 s37, s37, 10
    s_and_b32 s34, s34, 1
    s_lshl_b32 s34, s34, 3
    s_add_u32 s34, s34, s37
    v_add_u32 v201, s34, v1
    s_xor_b32 s34, s3, 2
    s_lshr_b32 s37, s34, 1
    s_lshl_b32 s37, s37, 10
    s_and_b32 s34, s34, 1
    s_lshl_b32 s34, s34, 3
    s_add_u32 s34, s34, s37
    v_add_u32 v202, s34, v1
    s_xor_b32 s34, s3, 3
    s_lshr_b32 s37, s34, 1
    s_lshl_b32 s37, s37, 10
    s_and_b32 s34, s34, 1
    s_lshl_b32 s34, s34, 3
    s_add_u32 s34, s34, s37
    v_add_u32 v203, s34, v1
    s_cmp_lg_u32 s3, 0
    s_cbranch_scc1 LPO_8
    s_lshl_b32 s40, s35, 8
    s_add_u32 s40, s40, s26
    s_add_u32 s40, s40, 12288
    s_mov_b32 s42, 0xffff
    s_mov_b32 s43, 0
    s_mov_b64 exec, s[42:43]
    s_mov_b32 s41, 0
LPL_8:
    buffer_load_dword v6, v5, s[8:11], s40 offen sc1
    s_add_u32 s41, s41, 1
    s_waitcnt vmcnt(0)
    v_cmp_ne_u32 vcc, 1, v6
    s_cmp_gt_u32 s41, 100000
    s_cbranch_scc1 LPX_8
    s_nop 2
    s_cbranch_vccnz LPL_8
LPX_8:
    s_mov_b64 exec, -1
LPO_8:
    s_barrier
    buffer_load_dwordx4 a[0:3], v10, s[8:11], s48 offen sc1
    buffer_load_dwordx4 a[4:7], v11, s[8:11], s48 offen sc1
    buffer_load_dwordx4 a[8:11], v12, s[8:11], s48 offen sc1
    buffer_load_dwordx4 a[12:15], v13, s[8:11], s48 offen sc1
    s_add_u32 s48, s48, 4096
    buffer_load_dwordx2 v[192:193], v8, s[8:11], s49 offen sc1
    buffer_load_dwordx2 v[194:195], v8, s[8:11], s49 offen offset:128 sc1
    buffer_load_dwordx4 a[16:19], v10, s[8:11], s48 offen sc1
    buffer_load_dwordx4 a[20:23], v11, s[8:11], s48 offen sc1
    buffer_load_dwordx4 a[24:27], v12, s[8:11], s48 offen sc1
    buffer_load_dwordx4 a[28:31], v13, s[8:11], s48 offen sc1
    s_add_u32 s48, s48, 4096
    buffer_load_dwordx4 a[32:35], v10, s[8:11], s48 offen sc1
    buffer_load_dwordx4 a[36:39], v11, s[8:11], s48 offen sc1
    buffer_load_dwordx4 a[40:43], v12, s[8:11], s48 offen sc1
    buffer_load_dwordx4 a[44:47], v13, s[8:11], s48 offen sc1
    s_add_u32 s48, s48, 4096
    buffer_load_dwordx2 a[48:49], v200, s[8:11], s48 offen sc1
    buffer_load_dwordx2 a[52:53], v201, s[8:11], s48 offen sc1
    buffer_load_dwordx2 a[56:57], v202, s[8:11], s48 offen sc1
    buffer_load_dwordx2 a[60:61], v203, s[8:11], s48 offen sc1
    s_add_u32 s48, s48, 2048
    buffer_load_dwordx4 a[64:67], v10, s[8:11], s48 offen sc1
    buffer_load_dwordx4 a[68:71], v11, s[8:11], s48 offen sc1
    buffer_load_dwordx4 a[72:75], v12, s[8:11], s48 offen sc1
    buffer_load_dwordx4 a[76:79], v13, s[8:11], s48 offen sc1
    s_add_u32 s48, s48, 4096
    buffer_load_dwordx4 a[80:83], v10, s[8:11], s48 offen sc1
    buffer_load_dwordx4 a[84:87], v11, s[8:11], s48 offen sc1
    buffer_load_dwordx4 a[88:91], v12, s[8:11], s48 offen sc1
    buffer_load_dwordx4 a[92:95], v13, s[8:11], s48 offen sc1
    s_add_u32 s48, s48, 4096
    s_waitcnt vmcnt(22)
    v_mfma_f32_16x16x32_bf16 v[32:35], a[128:131], a[4:7], 0
    v_mfma_f32_16x16x32_bf16 v[36:39], a[132:135], a[4:7], 0
    v_mfma_f32_16x16x32_bf16 v[40:43], a[136:139], a[4:7], 0
    v_mfma_f32_16x16x32_bf16 v[44:47], a[140:143], a[4:7], 0
    buffer_load_dwordx4 a[96:99], v10, s[8:11], s48 offen sc1
    buffer_load_dwordx4 a[100:103], v11, s[8:11], s48 offen sc1
    buffer_load_dwordx4 a[104:107], v12, s[8:11], s48 offen sc1
    buffer_load_dwordx4 a[108:111], v13, s[8:11], s48 offen sc1
    s_add_u32 s48, s48, 4096
    v_mfma_f32_16x16x32_bf16 v[48:51], a[128:131], a[8:11], 0
    v_mfma_f32_16x16x32_bf16 v[52:55], a[132:135], a[8:11], 0
    v_mfma_f32_16x16x32_bf16 v[56:59], a[136:139], a[8:11], 0
    v_mfma_f32_16x16x32_bf16 v[60:63], a[140:143], a[8:11], 0
    v_mfma_f32_16x16x32_bf16 v[64:67], a[128:131], a[12:15], 0
    v_mfma_f32_16x16x32_bf16 v[68:71], a[132:135], a[12:15], 0
    v_mfma_f32_16x16x32_bf16 v[72:75], a[136:139], a[12:15], 0
    v_mfma_f32_16x16x32_bf16 v[76:79], a[140:143], a[12:15], 0
    v_mfma_f32_16x16x32_bf16 v[16:19], a[128:131], a[0:3], 0
    v_mfma_f32_16x16x32_bf16 v[20:23], a[132:135], a[0:3], 0
    v_mfma_f32_16x16x32_bf16 v[24:27], a[136:139], a[0:3], 0
    v_mfma_f32_16x16x32_bf16 v[28:31], a[140:143], a[0:3], 0
    s_waitcnt vmcnt(20)
    v_mfma_f32_16x16x32_bf16 v[32:35], a[144:147], a[20:23], v[32:35]
    v_mfma_f32_16x16x32_bf16 v[36:39], a[148:151], a[20:23], v[36:39]
    v_mfma_f32_16x16x32_bf16 v[40:43], a[152:155], a[20:23], v[40:43]
    v_mfma_f32_16x16x32_bf16 v[44:47], a[156:159], a[20:23], v[44:47]
    buffer_load_dwordx2 a[112:113], v200, s[8:11], s48 offen sc1
    buffer_load_dwordx2 a[116:117], v201, s[8:11], s48 offen sc1
    buffer_load_dwordx2 a[120:121], v202, s[8:11], s48 offen sc1
    buffer_load_dwordx2 a[124:125], v203, s[8:11], s48 offen sc1
    s_add_u32 s48, s48, 2048
    v_mfma_f32_16x16x32_bf16 v[48:51], a[144:147], a[24:27], v[48:51]
    v_mfma_f32_16x16x32_bf16 v[52:55], a[148:151], a[24:27], v[52:55]
    v_mfma_f32_16x16x32_bf16 v[56:59], a[152:155], a[24:27], v[56:59]
    v_mfma_f32_16x16x32_bf16 v[60:63], a[156:159], a[24:27], v[60:63]
    v_mfma_f32_16x16x32_bf16 v[64:67], a[144:147], a[28:31], v[64:67]
    v_mfma_f32_16x16x32_bf16 v[68:71], a[148:151], a[28:31], v[68:71]
    v_mfma_f32_16x16x32_bf16 v[72:75], a[152:155], a[28:31], v[72:75]
    v_mfma_f32_16x16x32_bf16 v[76:79], a[156:159], a[28:31], v[76:79]
    v_mfma_f32_16x16x32_bf16 v[16:19], a[144:147], a[16:19], v[16:19]
    v_mfma_f32_16x16x32_bf16 v[20:23], a[148:151], a[16:19], v[20:23]
    v_mfma_f32_16x16x32_bf16 v[24:27], a[152:155], a[16:19], v[24:27]
    v_mfma_f32_16x16x32_bf16 v[28:31], a[156:159], a[16:19], v[28:31]
    s_waitcnt vmcnt(20)
    v_mfma_f32_16x16x32_bf16 v[32:35], a[160:163], a[36:39], v[32:35]
    v_mfma_f32_16x16x32_bf16 v[36:39], a[164:167], a[36:39], v[36:39]
    v_mfma_f32_16x16x32_bf16 v[40:43], a[168:171], a[36:39], v[40:43]
    v_mfma_f32_16x16x32_bf16 v[44:47], a[172:175], a[36:39], v[44:47]
    buffer_load_dwordx4 a[0:3], v10, s[8:11], s48 offen sc1
    buffer_load_dwordx4 a[4:7], v11, s[8:11], s48 offen sc1
    buffer_load_dwordx4 a[8:11], v12, s[8:11], s48 offen sc1
    buffer_load_dwordx4 a[12:15], v13, s[8:11], s48 offen sc1
    s_add_u32 s48, s48, 4096
    v_mfma_f32_16x16x32_bf16 v[48:51], a[160:163], a[40:43], v[48:51]
    v_mfma_f32_16x16x32_bf16 v[52:55], a[164:167], a[40:43], v[52:55]
    v_mfma_f32_16x16x32_bf16 v[56:59], a[168:171], a[40:43], v[56:59]
    v_mfma_f32_16x16x32_bf16 v[60:63], a[172:175], a[40:43], v[60:63]
    v_mfma_f32_16x16x32_bf16 v[64:67], a[160:163], a[44:47], v[64:67]
    v_mfma_f32_16x16x32_bf16 v[68:71], a[164:167], a[44:47], v[68:71]
    v_mfma_f32_16x16x32_bf16 v[72:75], a[168:171], a[44:47], v[72:75]
    v_mfma_f32_16x16x32_bf16 v[76:79], a[172:175], a[44:47], v[76:79]
    v_mfma_f32_16x16x32_bf16 v[16:19], a[160:163], a[32:35], v[16:19]
    v_mfma_f32_16x16x32_bf16 v[20:23], a[164:167], a[32:35], v[20:23]
    v_mfma_f32_16x16x32_bf16 v[24:27], a[168:171], a[32:35], v[24:27]
    v_mfma_f32_16x16x32_bf16 v[28:31], a[172:175], a[32:35], v[28:31]
    v_add_f32 v192, v192, v194
    v_add_f32 v193, v193, v195
    v_mov_b32 v196, v192
    v_mov_b32 v197, v193
    s_nop 1
    v_permlane32_swap_b32 v192, v196
    v_permlane32_swap_b32 v193, v197
    s_nop 1
    v_add_f32 v192, v192, v196
    v_add_f32 v193, v193, v197
    v_mov_b32 v196, v192
    v_mov_b32 v197, v193
    s_nop 1
    v_permlane16_swap_b32 v192, v196
    v_permlane16_swap_b32 v193, v197
    s_nop 1
    v_add_f32 v192, v192, v196
    v_add_f32 v193, v193, v197
    v_mul_f32 v198, 0xbb000000, v192
    v_mul_f32 v194, v198, v198
    v_mov_b32 v195, 0x3b000000
    v_fma_f32 v194, v193, v195, -v194
    v_max_f32 v194, 0, v194
    v_add_f32 v194, 0x3727c5ac, v194
    v_rsq_f32 v199, v194
    s_nop 0
    v_mul_f32 v199, v199, v199
    s_lshl_b32 s44, s20, 2
    s_add_u32 s44, s44, s3
    s_and_b32 s45, s44, 1
    s_lshr_b32 s44, s44, 1
    s_lshl_b32 s44, s44, 4
    s_lshl_b32 s46, s21, 1
    s_add_u32 s44, s44, s46
    s_lshl_b32 s44, s44, 1
    s_add_u32 s44, s44, s45
    s_lshl_b32 s44, s44, 10
    s_add_u32 s44, s44, 0x1e00000
    s_add_u32 s44, s44, s24
    s_lshl_b32 s47, s20, 2
    s_add_u32 s47, s47, s3
    s_lshl_b32 s47, s47, 10
    s_lshl_b32 s31, s21, 7
    s_add_u32 s47, s47, s31
    s_add_u32 s47, s47, s24
    s_add_u32 s47, s47, 0x3180000
    s_lshr_b32 s35, s20, 1
    s_and_b32 s36, s20, 1
    s_lshl_b32 s36, s36, 3
    s_add_u32 s36, s36, s21
    s_waitcnt vmcnt(20)
    v_mfma_f32_16x16x16_bf16 v[32:35], a[176:177], a[52:53], v[32:35]
    v_mfma_f32_16x16x16_bf16 v[36:39], a[178:179], a[52:53], v[36:39]
    v_mfma_f32_16x16x16_bf16 v[40:43], a[180:181], a[52:53], v[40:43]
    v_mfma_f32_16x16x16_bf16 v[44:47], a[182:183], a[52:53], v[44:47]
    buffer_load_dwordx4 a[16:19], v10, s[8:11], s48 offen sc1
    buffer_load_dwordx4 a[20:23], v11, s[8:11], s48 offen sc1
    buffer_load_dwordx4 a[24:27], v12, s[8:11], s48 offen sc1
    buffer_load_dwordx4 a[28:31], v13, s[8:11], s48 offen sc1
    s_add_u32 s48, s48, 4096
    v_mfma_f32_16x16x16_bf16 v[48:51], a[176:177], a[56:57], v[48:51]
    v_mfma_f32_16x16x16_bf16 v[52:55], a[178:179], a[56:57], v[52:55]
    v_mfma_f32_16x16x16_bf16 v[56:59], a[180:181], a[56:57], v[56:59]
    v_mfma_f32_16x16x16_bf16 v[60:63], a[182:183], a[56:57], v[60:63]
    v_mfma_f32_16x16x16_bf16 v[64:67], a[176:177], a[60:61], v[64:67]
    v_mfma_f32_16x16x16_bf16 v[68:71], a[178:179], a[60:61], v[68:71]
    v_mfma_f32_16x16x16_bf16 v[72:75], a[180:181], a[60:61], v[72:75]
    v_mfma_f32_16x16x16_bf16 v[76:79], a[182:183], a[60:61], v[76:79]
    v_mfma_f32_16x16x16_bf16 v[16:19], a[176:177], a[48:49], v[16:19]
    v_mfma_f32_16x16x16_bf16 v[20:23], a[178:179], a[48:49], v[20:23]
    v_mfma_f32_16x16x16_bf16 v[24:27], a[180:181], a[48:49], v[24:27]
    v_mfma_f32_16x16x16_bf16 v[28:31], a[182:183], a[48:49], v[28:31]
    s_waitcnt vmcnt(20)
    v_mfma_f32_16x16x32_bf16 v[32:35], a[184:187], a[68:71], v[32:35]
    v_mfma_f32_16x16x32_bf16 v[36:39], a[188:191], a[68:71], v[36:39]
    v_mfma_f32_16x16x32_bf16 v[40:43], a[192:195], a[68:71], v[40:43]
    v_mfma_f32_16x16x32_bf16 v[44:47], a[196:199], a[68:71], v[44:47]
    buffer_load_dwordx4 a[32:35], v10, s[8:11], s48 offen sc1
    buffer_load_dwordx4 a[36:39], v11, s[8:11], s48 offen sc1
    buffer_load_dwordx4 a[40:43], v12, s[8:11], s48 offen sc1
    buffer_load_dwordx4 a[44:47], v13, s[8:11], s48 offen sc1
    s_add_u32 s48, s48, 4096
    v_mfma_f32_16x16x32_bf16 v[48:51], a[184:187], a[72:75], v[48:51]
    v_mfma_f32_16x16x32_bf16 v[52:55], a[188:191], a[72:75], v[52:55]
    v_mfma_f32_16x16x32_bf16 v[56:59], a[192:195], a[72:75], v[56:59]
    v_mfma_f32_16x16x32_bf16 v[60:63], a[196:199], a[72:75], v[60:63]
    v_mfma_f32_16x16x32_bf16 v[64:67], a[184:187], a[76:79], v[64:67]
    v_mfma_f32_16x16x32_bf16 v[68:71], a[188:191], a[76:79], v[68:71]
    v_mfma_f32_16x16x32_bf16 v[72:75], a[192:195], a[76:79], v[72:75]
    v_mfma_f32_16x16x32_bf16 v[76:79], a[196:199], a[76:79], v[76:79]
    v_mfma_f32_16x16x32_bf16 v[16:19], a[184:187], a[64:67], v[16:19]
    v_mfma_f32_16x16x32_bf16 v[20:23], a[188:191], a[64:67], v[20:23]
    v_mfma_f32_16x16x32_bf16 v[24:27], a[192:195], a[64:67], v[24:27]
    v_mfma_f32_16x16x32_bf16 v[28:31], a[196:199], a[64:67], v[28:31]
    s_waitcnt vmcnt(20)
    v_mfma_f32_16x16x32_bf16 v[32:35], a[200:203], a[84:87], v[32:35]
    v_mfma_f32_16x16x32_bf16 v[36:39], a[204:207], a[84:87], v[36:39]
    v_mfma_f32_16x16x32_bf16 v[40:43], a[208:211], a[84:87], v[40:43]
    v_mfma_f32_16x16x32_bf16 v[44:47], a[212:215], a[84:87], v[44:47]
    buffer_load_dwordx2 a[48:49], v200, s[8:11], s48 offen sc1
    buffer_load_dwordx2 a[52:53], v201, s[8:11], s48 offen sc1
    buffer_load_dwordx2 a[56:57], v202, s[8:11], s48 offen sc1
    buffer_load_dwordx2 a[60:61], v203, s[8:11], s48 offen sc1
    s_add_u32 s48, s48, 2048
    v_mfma_f32_16x16x32_bf16 v[48:51], a[200:203], a[88:91], v[48:51]
    v_mfma_f32_16x16x32_bf16 v[52:55], a[204:207], a[88:91], v[52:55]
    v_mfma_f32_16x16x32_bf16 v[56:59], a[208:211], a[88:91], v[56:59]
    v_mfma_f32_16x16x32_bf16 v[60:63], a[212:215], a[88:91], v[60:63]
    v_mfma_f32_16x16x32_bf16 v[64:67], a[200:203], a[92:95], v[64:67]
    v_mfma_f32_16x16x32_bf16 v[68:71], a[204:207], a[92:95], v[68:71]
    v_mfma_f32_16x16x32_bf16 v[72:75], a[208:211], a[92:95], v[72:75]
    v_mfma_f32_16x16x32_bf16 v[76:79], a[212:215], a[92:95], v[76:79]
    v_mfma_f32_16x16x32_bf16 v[16:19], a[200:203], a[80:83], v[16:19]
    v_mfma_f32_16x16x32_bf16 v[20:23], a[204:207], a[80:83], v[20:23]
    v_mfma_f32_16x16x32_bf16 v[24:27], a[208:211], a[80:83], v[24:27]
    v_mfma_f32_16x16x32_bf16 v[28:31], a[212:215], a[80:83], v[28:31]
    s_waitcnt vmcnt(20)
    v_mfma_f32_16x16x32_bf16 v[32:35], a[216:219], a[100:103], v[32:35]
    v_mfma_f32_16x16x32_bf16 v[36:39], a[220:223], a[100:103], v[36:39]
    v_mfma_f32_16x16x32_bf16 v[40:43], a[224:227], a[100:103], v[40:43]
    v_mfma_f32_16x16x32_bf16 v[44:47], a[228:231], a[100:103], v[44:47]
    buffer_load_dwordx4 a[64:67], v10, s[8:11], s48 offen sc1
    buffer_load_dwordx4 a[68:71], v11, s[8:11], s48 offen sc1
    buffer_load_dwordx4 a[72:75], v12, s[8:11], s48 offen sc1
    buffer_load_dwordx4 a[76:79], v13, s[8:11], s48 offen sc1
    s_add_u32 s48, s48, 4096
    v_mfma_f32_16x16x32_bf16 v[48:51], a[216:219], a[104:107], v[48:51]
    v_mfma_f32_16x16x32_bf16 v[52:55], a[220:223], a[104:107], v[52:55]
    v_mfma_f32_16x16x32_bf16 v[56:59], a[224:227], a[104:107], v[56:59]
    v_mfma_f32_16x16x32_bf16 v[60:63], a[228:231], a[104:107], v[60:63]
    v_mfma_f32_16x16x32_bf16 v[64:67], a[216:219], a[108:111], v[64:67]
    v_mfma_f32_16x16x32_bf16 v[68:71], a[220:223], a[108:111], v[68:71]
    v_mfma_f32_16x16x32_bf16 v[72:75], a[224:227], a[108:111], v[72:75]
    v_mfma_f32_16x16x32_bf16 v[76:79], a[228:231], a[108:111], v[76:79]
    v_mfma_f32_16x16x32_bf16 v[16:19], a[216:219], a[96:99], v[16:19]
    v_mfma_f32_16x16x32_bf16 v[20:23], a[220:223], a[96:99], v[20:23]
    v_mfma_f32_16x16x32_bf16 v[24:27], a[224:227], a[96:99], v[24:27]
    v_mfma_f32_16x16x32_bf16 v[28:31], a[228:231], a[96:99], v[28:31]
    s_waitcnt vmcnt(20)
    v_mfma_f32_16x16x16_bf16 v[32:35], a[232:233], a[116:117], v[32:35]
    v_mfma_f32_16x16x16_bf16 v[36:39], a[234:235], a[116:117], v[36:39]
    v_mfma_f32_16x16x16_bf16 v[40:43], a[236:237], a[116:117], v[40:43]
    v_mfma_f32_16x16x16_bf16 v[44:47], a[238:239], a[116:117], v[44:47]
    buffer_load_dwordx4 a[80:83], v10, s[8:11], s48 offen sc1
    buffer_load_dwordx4 a[84:87], v11, s[8:11], s48 offen sc1
    buffer_load_dwordx4 a[88:91], v12, s[8:11], s48 offen sc1
    buffer_load_dwordx4 a[92:95], v13, s[8:11], s48 offen sc1
    s_add_u32 s48, s48, 4096
    v_mfma_f32_16x16x16_bf16 v[48:51], a[232:233], a[120:121], v[48:51]
    v_mfma_f32_16x16x16_bf16 v[52:55], a[234:235], a[120:121], v[52:55]
    v_mfma_f32_16x16x16_bf16 v[56:59], a[236:237], a[120:121], v[56:59]
    v_mfma_f32_16x16x16_bf16 v[60:63], a[238:239], a[120:121], v[60:63]
    v_mfma_f32_16x16x16_bf16 v[64:67], a[232:233], a[124:125], v[64:67]
    v_mfma_f32_16x16x16_bf16 v[68:71], a[234:235], a[124:125], v[68:71]
    v_mfma_f32_16x16x16_bf16 v[72:75], a[236:237], a[124:125], v[72:75]
    v_mfma_f32_16x16x16_bf16 v[76:79], a[238:239], a[124:125], v[76:79]
    v_mfma_f32_16x16x16_bf16 v[16:19], a[232:233], a[112:113], v[16:19]
    v_mfma_f32_16x16x16_bf16 v[20:23], a[234:235], a[112:113], v[20:23]
    v_mfma_f32_16x16x16_bf16 v[24:27], a[236:237], a[112:113], v[24:27]
    v_mfma_f32_16x16x16_bf16 v[28:31], a[238:239], a[112:113], v[28:31]
    s_waitcnt vmcnt(20)
    v_mfma_f32_16x16x32_bf16 v[32:35], a[240:243], a[4:7], v[32:35]
    v_mfma_f32_16x16x32_bf16 v[36:39], a[244:247], a[4:7], v[36:39]
    v_mfma_f32_16x16x32_bf16 v[40:43], a[248:251], a[4:7], v[40:43]
    v_mfma_f32_16x16x32_bf16 v[44:47], a[252:255], a[4:7], v[44:47]
    buffer_load_dwordx4 a[96:99], v10, s[8:11], s48 offen sc1
    buffer_load_dwordx4 a[100:103], v11, s[8:11], s48 offen sc1
    buffer_load_dwordx4 a[104:107], v12, s[8:11], s48 offen sc1
    buffer_load_dwordx4 a[108:111], v13, s[8:11], s48 offen sc1
    s_add_u32 s48, s48, 4096
    v_mfma_f32_16x16x32_bf16 v[48:51], a[240:243], a[8:11], v[48:51]
    v_mfma_f32_16x16x32_bf16 v[52:55], a[244:247], a[8:11], v[52:55]
    v_mfma_f32_16x16x32_bf16 v[56:59], a[248:251], a[8:11], v[56:59]
    v_mfma_f32_16x16x32_bf16 v[60:63], a[252:255], a[8:11], v[60:63]
    v_mfma_f32_16x16x32_bf16 v[64:67], a[240:243], a[12:15], v[64:67]
    v_mfma_f32_16x16x32_bf16 v[68:71], a[244:247], a[12:15], v[68:71]
    v_mfma_f32_16x16x32_bf16 v[72:75], a[248:251], a[12:15], v[72:75]
    v_mfma_f32_16x16x32_bf16 v[76:79], a[252:255], a[12:15], v[76:79]
    v_mfma_f32_16x16x32_bf16 v[16:19], a[240:243], a[0:3], v[16:19]
    v_mfma_f32_16x16x32_bf16 v[20:23], a[244:247], a[0:3], v[20:23]
    v_mfma_f32_16x16x32_bf16 v[24:27], a[248:251], a[0:3], v[24:27]
    v_mfma_f32_16x16x32_bf16 v[28:31], a[252:255], a[0:3], v[28:31]
    s_waitcnt vmcnt(20)
    v_mfma_f32_16x16x32_bf16 v[32:35], v[212:215], a[20:23], v[32:35]
    v_mfma_f32_16x16x32_bf16 v[36:39], v[216:219], a[20:23], v[36:39]
    v_mfma_f32_16x16x32_bf16 v[40:43], v[220:223], a[20:23], v[40:43]
    v_mfma_f32_16x16x32_bf16 v[44:47], v[224:227], a[20:23], v[44:47]
    buffer_load_dwordx2 a[112:113], v200, s[8:11], s48 offen sc1
    buffer_load_dwordx2 a[116:117], v201, s[8:11], s48 offen sc1
    buffer_load_dwordx2 a[120:121], v202, s[8:11], s48 offen sc1
    buffer_load_dwordx2 a[124:125], v203, s[8:11], s48 offen sc1
    s_add_u32 s48, s48, 2048
    v_mfma_f32_16x16x32_bf16 v[48:51], v[212:215], a[24:27], v[48:51]
    v_mfma_f32_16x16x32_bf16 v[52:55], v[216:219], a[24:27], v[52:55]
    v_mfma_f32_16x16x32_bf16 v[56:59], v[220:223], a[24:27], v[56:59]
    v_mfma_f32_16x16x32_bf16 v[60:63], v[224:227], a[24:27], v[60:63]
    v_mfma_f32_16x16x32_bf16 v[64:67], v[212:215], a[28:31], v[64:67]
    v_mfma_f32_16x16x32_bf16 v[68:71], v[216:219], a[28:31], v[68:71]
    v_mfma_f32_16x16x32_bf16 v[72:75], v[220:223], a[28:31], v[72:75]
    v_mfma_f32_16x16x32_bf16 v[76:79], v[224:227], a[28:31], v[76:79]
    v_mfma_f32_16x16x32_bf16 v[16:19], v[212:215], a[16:19], v[16:19]
    v_mfma_f32_16x16x32_bf16 v[20:23], v[216:219], a[16:19], v[20:23]
    v_mfma_f32_16x16x32_bf16 v[24:27], v[220:223], a[16:19], v[24:27]
    v_mfma_f32_16x16x32_bf16 v[28:31], v[224:227], a[16:19], v[28:31]
    s_waitcnt vmcnt(20)
    v_mfma_f32_16x16x32_bf16 v[32:35], v[228:231], a[36:39], v[32:35]
    v_mfma_f32_16x16x32_bf16 v[36:39], v[232:235], a[36:39], v[36:39]
    v_mfma_f32_16x16x32_bf16 v[40:43], v[236:239], a[36:39], v[40:43]
    v_mfma_f32_16x16x32_bf16 v[44:47], v[240:243], a[36:39], v[44:47]
    v_mfma_f32_16x16x32_bf16 v[48:51], v[228:231], a[40:43], v[48:51]
    v_mfma_f32_16x16x32_bf16 v[52:55], v[232:235], a[40:43], v[52:55]
    v_mfma_f32_16x16x32_bf16 v[56:59], v[236:239], a[40:43], v[56:59]
    v_mfma_f32_16x16x32_bf16 v[60:63], v[240:243], a[40:43], v[60:63]
    v_mfma_f32_16x16x32_bf16 v[64:67], v[228:231], a[44:47], v[64:67]
    v_mfma_f32_16x16x32_bf16 v[68:71], v[232:235], a[44:47], v[68:71]
    v_mfma_f32_16x16x32_bf16 v[72:75], v[236:239], a[44:47], v[72:75]
    v_mfma_f32_16x16x32_bf16 v[76:79], v[240:243], a[44:47], v[76:79]
    v_mfma_f32_16x16x32_bf16 v[16:19], v[228:231], a[32:35], v[16:19]
    v_mfma_f32_16x16x32_bf16 v[20:23], v[232:235], a[32:35], v[20:23]
    v_mfma_f32_16x16x32_bf16 v[24:27], v[236:239], a[32:35], v[24:27]
    v_mfma_f32_16x16x32_bf16 v[28:31], v[240:243], a[32:35], v[28:31]
    s_waitcnt vmcnt(16)
    v_mfma_f32_16x16x16_bf16 v[32:35], v[128:129], a[52:53], v[32:35]
    v_mfma_f32_16x16x16_bf16 v[36:39], v[130:131], a[52:53], v[36:39]
    v_mfma_f32_16x16x16_bf16 v[40:43], v[132:133], a[52:53], v[40:43]
    v_mfma_f32_16x16x16_bf16 v[44:47], v[134:135], a[52:53], v[44:47]
    v_mfma_f32_16x16x16_bf16 v[48:51], v[128:129], a[56:57], v[48:51]
    v_mfma_f32_16x16x16_bf16 v[52:55], v[130:131], a[56:57], v[52:55]
    v_mfma_f32_16x16x16_bf16 v[56:59], v[132:133], a[56:57], v[56:59]
    v_mfma_f32_16x16x16_bf16 v[60:63], v[134:135], a[56:57], v[60:63]
    v_mfma_f32_16x16x16_bf16 v[64:67], v[128:129], a[60:61], v[64:67]
    v_mfma_f32_16x16x16_bf16 v[68:71], v[130:131], a[60:61], v[68:71]
    v_mfma_f32_16x16x16_bf16 v[72:75], v[132:133], a[60:61], v[72:75]
    v_mfma_f32_16x16x16_bf16 v[76:79], v[134:135], a[60:61], v[76:79]
    v_mfma_f32_16x16x16_bf16 v[16:19], v[128:129], a[48:49], v[16:19]
    v_mfma_f32_16x16x16_bf16 v[20:23], v[130:131], a[48:49], v[20:23]
    v_mfma_f32_16x16x16_bf16 v[24:27], v[132:133], a[48:49], v[24:27]
    v_mfma_f32_16x16x16_bf16 v[28:31], v[134:135], a[48:49], v[28:31]
    s_waitcnt vmcnt(12)
    v_mfma_f32_16x16x32_bf16 v[32:35], v[136:139], a[68:71], v[32:35]
    v_mfma_f32_16x16x32_bf16 v[36:39], v[140:143], a[68:71], v[36:39]
    v_mfma_f32_16x16x32_bf16 v[40:43], v[144:147], a[68:71], v[40:43]
    v_mfma_f32_16x16x32_bf16 v[44:47], v[148:151], a[68:71], v[44:47]
    v_mfma_f32_16x16x32_bf16 v[48:51], v[136:139], a[72:75], v[48:51]
    v_mfma_f32_16x16x32_bf16 v[52:55], v[140:143], a[72:75], v[52:55]
    v_mfma_f32_16x16x32_bf16 v[56:59], v[144:147], a[72:75], v[56:59]
    v_mfma_f32_16x16x32_bf16 v[60:63], v[148:151], a[72:75], v[60:63]
    v_mfma_f32_16x16x32_bf16 v[64:67], v[136:139], a[76:79], v[64:67]
    v_mfma_f32_16x16x32_bf16 v[68:71], v[140:143], a[76:79], v[68:71]
    v_mfma_f32_16x16x32_bf16 v[72:75], v[144:147], a[76:79], v[72:75]
    v_mfma_f32_16x16x32_bf16 v[76:79], v[148:151], a[76:79], v[76:79]
    v_mfma_f32_16x16x32_bf16 v[16:19], v[136:139], a[64:67], v[16:19]
    v_mfma_f32_16x16x32_bf16 v[20:23], v[140:143], a[64:67], v[20:23]
    v_mfma_f32_16x16x32_bf16 v[24:27], v[144:147], a[64:67], v[24:27]
    v_mfma_f32_16x16x32_bf16 v[28:31], v[148:151], a[64:67], v[28:31]
    s_waitcnt vmcnt(8)
    v_mfma_f32_16x16x32_bf16 v[32:35], v[152:155], a[84:87], v[32:35]
    v_mfma_f32_16x16x32_bf16 v[36:39], v[156:159], a[84:87], v[36:39]
    v_mfma_f32_16x16x32_bf16 v[40:43], v[160:163], a[84:87], v[40:43]
    v_mfma_f32_16x16x32_bf16 v[44:47], v[164:167], a[84:87], v[44:47]
    v_mfma_f32_16x16x32_bf16 v[48:51], v[152:155], a[88:91], v[48:51]
    v_mfma_f32_16x16x32_bf16 v[52:55], v[156:159], a[88:91], v[52:55]
    v_mfma_f32_16x16x32_bf16 v[56:59], v[160:163], a[88:91], v[56:59]
    v_mfma_f32_16x16x32_bf16 v[60:63], v[164:167], a[88:91], v[60:63]
    v_mfma_f32_16x16x32_bf16 v[64:67], v[152:155], a[92:95], v[64:67]
    v_mfma_f32_16x16x32_bf16 v[68:71], v[156:159], a[92:95], v[68:71]
    v_mfma_f32_16x16x32_bf16 v[72:75], v[160:163], a[92:95], v[72:75]
    v_mfma_f32_16x16x32_bf16 v[76:79], v[164:167], a[92:95], v[76:79]
    v_mfma_f32_16x16x32_bf16 v[16:19], v[152:155], a[80:83], v[16:19]
    v_mfma_f32_16x16x32_bf16 v[20:23], v[156:159], a[80:83], v[20:23]
    v_mfma_f32_16x16x32_bf16 v[24:27], v[160:163], a[80:83], v[24:27]
    v_mfma_f32_16x16x32_bf16 v[28:31], v[164:167], a[80:83], v[28:31]
    s_waitcnt vmcnt(4)
    v_mfma_f32_16x16x32_bf16 v[32:35], v[168:171], a[100:103], v[32:35]
    v_mfma_f32_16x16x32_bf16 v[36:39], v[172:175], a[100:103], v[36:39]
    v_mfma_f32_16x16x32_bf16 v[40:43], v[176:179], a[100:103], v[40:43]
    v_mfma_f32_16x16x32_bf16 v[44:47], v[180:183], a[100:103], v[44:47]
    v_mfma_f32_16x16x32_bf16 v[48:51], v[168:171], a[104:107], v[48:51]
    v_mfma_f32_16x16x32_bf16 v[52:55], v[172:175], a[104:107], v[52:55]
    v_mfma_f32_16x16x32_bf16 v[56:59], v[176:179], a[104:107], v[56:59]
    v_mfma_f32_16x16x32_bf16 v[60:63], v[180:183], a[104:107], v[60:63]
    v_mfma_f32_16x16x32_bf16 v[64:67], v[168:171], a[108:111], v[64:67]
    v_mfma_f32_16x16x32_bf16 v[68:71], v[172:175], a[108:111], v[68:71]
    v_mfma_f32_16x16x32_bf16 v[72:75], v[176:179], a[108:111], v[72:75]
    v_mfma_f32_16x16x32_bf16 v[76:79], v[180:183], a[108:111], v[76:79]
    v_mfma_f32_16x16x32_bf16 v[16:19], v[168:171], a[96:99], v[16:19]
    v_mfma_f32_16x16x32_bf16 v[20:23], v[172:175], a[96:99], v[20:23]
    v_mfma_f32_16x16x32_bf16 v[24:27], v[176:179], a[96:99], v[24:27]
    v_mfma_f32_16x16x32_bf16 v[28:31], v[180:183], a[96:99], v[28:31]
    s_waitcnt vmcnt(0)
    v_mfma_f32_16x16x16_bf16 v[32:35], v[184:185], a[116:117], v[32:35]
    v_mfma_f32_16x16x16_bf16 v[36:39], v[186:187], a[116:117], v[36:39]
    v_mfma_f32_16x16x16_bf16 v[40:43], v[188:189], a[116:117], v[40:43]
    v_mfma_f32_16x16x16_bf16 v[44:47], v[190:191], a[116:117], v[44:47]
    v_mfma_f32_16x16x16_bf16 v[48:51], v[184:185], a[120:121], v[48:51]
    v_mfma_f32_16x16x16_bf16 v[52:55], v[186:187], a[120:121], v[52:55]
    v_mfma_f32_16x16x16_bf16 v[56:59], v[188:189], a[120:121], v[56:59]
    v_mfma_f32_16x16x16_bf16 v[60:63], v[190:191], a[120:121], v[60:63]
    v_mfma_f32_16x16x16_bf16 v[64:67], v[184:185], a[124:125], v[64:67]
    v_mfma_f32_16x16x16_bf16 v[68:71], v[186:187], a[124:125], v[68:71]
    v_mfma_f32_16x16x16_bf16 v[72:75], v[188:189], a[124:125], v[72:75]
    v_mfma_f32_16x16x16_bf16 v[76:79], v[190:191], a[124:125], v[76:79]
    v_mfma_f32_16x16x16_bf16 v[16:19], v[184:185], a[112:113], v[16:19]
    v_mfma_f32_16x16x16_bf16 v[20:23], v[186:187], a[112:113], v[20:23]
    v_mfma_f32_16x16x16_bf16 v[24:27], v[188:189], a[112:113], v[24:27]
    v_mfma_f32_16x16x16_bf16 v[28:31], v[190:191], a[112:113], v[28:31]
    ds_write_b128 v208, v[32:35] offset:0
    ds_write_b128 v208, v[36:39] offset:1024
    ds_write_b128 v208, v[40:43] offset:2048
    ds_write_b128 v208, v[44:47] offset:3072
    ds_write_b128 v209, v[48:51] offset:0
    ds_write_b128 v209, v[52:55] offset:1024
    ds_write_b128 v209, v[56:59] offset:2048
    ds_write_b128 v209, v[60:63] offset:3072
    s_nop 3
    ds_write_b128 v210, v[64:67] offset:0
    ds_write_b128 v210, v[68:71] offset:1024
    ds_write_b128 v210, v[72:75] offset:2048
    ds_write_b128 v210, v[76:79] offset:3072
    v_lshlrev_b32 v128, 16, v248
    v_and_b32 v129, 0xffff0000, v248
    v_lshlrev_b32 v130, 16, v249
    v_and_b32 v131, 0xffff0000, v249
    v_lshlrev_b32 v132, 16, v250
    v_and_b32 v133, 0xffff0000, v250
    v_lshlrev_b32 v134, 16, v251
    v_and_b32 v135, 0xffff0000, v251
    v_lshlrev_b32 v136, 16, v252
    v_and_b32 v137, 0xffff0000, v252
    v_lshlrev_b32 v138, 16, v253
    v_and_b32 v139, 0xffff0000, v253
    v_lshlrev_b32 v140, 16, v254
    v_and_b32 v141, 0xffff0000, v254
    v_lshlrev_b32 v142, 16, v255
    v_and_b32 v143, 0xffff0000, v255
    s_waitcnt lgkmcnt(0)
    s_barrier
    ds_read_b128 v[80:83], v211 offset:0
    ds_read_b128 v[84:87], v211 offset:1024
    ds_read_b128 v[88:91], v211 offset:2048
    ds_read_b128 v[92:95], v211 offset:3072
    ds_read_b128 v[96:99], v211 offset:4096
    ds_read_b128 v[100:103], v211 offset:5120
    ds_read_b128 v[104:107], v211 offset:6144
    ds_read_b128 v[108:111], v211 offset:7168
    ds_read_b128 v[112:115], v211 offset:8192
    ds_read_b128 v[116:119], v211 offset:9216
    ds_read_b128 v[120:123], v211 offset:10240
    ds_read_b128 v[124:127], v211 offset:11264
    s_waitcnt lgkmcnt(8)
    v_add_f32 v16, v16, v80
    v_add_f32 v17, v17, v81
    v_add_f32 v18, v18, v82
    v_add_f32 v19, v19, v83
    v_add_f32 v20, v20, v84
    v_add_f32 v21, v21, v85
    v_add_f32 v22, v22, v86
    v_add_f32 v23, v23, v87
    v_add_f32 v24, v24, v88
    v_add_f32 v25, v25, v89
    v_add_f32 v26, v26, v90
    v_add_f32 v27, v27, v91
    v_add_f32 v28, v28, v92
    v_add_f32 v29, v29, v93
    v_add_f32 v30, v30, v94
    v_add_f32 v31, v31, v95
    s_waitcnt lgkmcnt(0)
    v_add_f32 v96, v96, v112
    v_add_f32 v97, v97, v113
    v_add_f32 v98, v98, v114
    v_add_f32 v99, v99, v115
    v_add_f32 v100, v100, v116
    v_add_f32 v101, v101, v117
    v_add_f32 v102, v102, v118
    v_add_f32 v103, v103, v119
    v_add_f32 v104, v104, v120
    v_add_f32 v105, v105, v121
    v_add_f32 v106, v106, v122
    v_add_f32 v107, v107, v123
    v_add_f32 v108, v108, v124
    v_add_f32 v109, v109, v125
    v_add_f32 v110, v110, v126
    v_add_f32 v111, v111, v127
    v_add_f32 v16, v16, v96
    v_add_f32 v17, v17, v97
    v_add_f32 v18, v18, v98
    v_add_f32 v19, v19, v99
    v_add_f32 v20, v20, v100
    v_add_f32 v21, v21, v101
    v_add_f32 v22, v22, v102
    v_add_f32 v23, v23, v103
    v_add_f32 v24, v24, v104
    v_add_f32 v25, v25, v105
    v_add_f32 v26, v26, v106
    v_add_f32 v27, v27, v107
    v_add_f32 v28, v28, v108
    v_add_f32 v29, v29, v109
    v_add_f32 v30, v30, v110
    v_add_f32 v31, v31, v111
    v_fma_f32 v16, v16, v199, v128
    v_fma_f32 v17, v17, v199, v129
    v_cvt_pk_bf16_f32 v248, v16, v17
    v_fma_f32 v18, v18, v199, v130
    v_fma_f32 v19, v19, v199, v131
    v_cvt_pk_bf16_f32 v249, v18, v19
    v_fma_f32 v20, v20, v199, v132
    v_fma_f32 v21, v21, v199, v133
    v_cvt_pk_bf16_f32 v250, v20, v21
    v_fma_f32 v22, v22, v199, v134
    v_fma_f32 v23, v23, v199, v135
    v_cvt_pk_bf16_f32 v251, v22, v23
    v_fma_f32 v24, v24, v199, v136
    v_fma_f32 v25, v25, v199, v137
    v_cvt_pk_bf16_f32 v252, v24, v25
    v_fma_f32 v26, v26, v199, v138
    v_fma_f32 v27, v27, v199, v139
    v_cvt_pk_bf16_f32 v253, v26, v27
    v_fma_f32 v28, v28, v199, v140
    v_fma_f32 v29, v29, v199, v141
    v_cvt_pk_bf16_f32 v254, v28, v29
    v_fma_f32 v30, v30, v199, v142
    v_fma_f32 v31, v31, v199, v143
    v_cvt_pk_bf16_f32 v255, v30, v31
    s_cmp_lg_u32 s25, 0
    s_cbranch_scc1 LM_final
    buffer_store_dwordx4 v[248:251], v1, s[8:11], s44 offen sc1
    buffer_store_dwordx4 v[252:255], v1, s[8:11], s44 offen offset:2048 sc1
    v_mov_b32 v206, 0x3f803f80
    v_mov_b32 v202, 0
    v_mov_b32 v203, 0
    v_dot2_f32_bf16 v202, v248, v206, v202
    v_dot2_f32_bf16 v203, v248, v248, v203
    v_dot2_f32_bf16 v202, v249, v206, v202
    v_dot2_f32_bf16 v203, v249, v249, v203
    v_dot2_f32_bf16 v202, v250, v206, v202
    v_dot2_f32_bf16 v203, v250, v250, v203
    v_dot2_f32_bf16 v202, v251, v206, v202
    v_dot2_f32_bf16 v203, v251, v251, v203
    v_dot2_f32_bf16 v202, v252, v206, v202
    v_dot2_f32_bf16 v203, v252, v252, v203
    v_dot2_f32_bf16 v202, v253, v206, v202
    v_dot2_f32_bf16 v203, v253, v253, v203
    v_dot2_f32_bf16 v202, v254, v206, v202
    v_dot2_f32_bf16 v203, v254, v254, v203
    v_dot2_f32_bf16 v202, v255, v206, v202
    v_dot2_f32_bf16 v203, v255, v255, v203
    s_nop 3
    v_mov_b32 v204, v202
    v_mov_b32 v205, v203
    s_nop 1
    v_permlane32_swap_b32 v202, v204
    v_permlane32_swap_b32 v203, v205
    s_nop 1
    v_add_f32 v202, v202, v204
    v_add_f32 v203, v203, v205
    v_mov_b32 v204, v202
    v_mov_b32 v205, v203
    s_nop 1
    v_permlane16_swap_b32 v202, v204
    v_permlane16_swap_b32 v203, v205
    s_nop 1
    v_add_f32 v202, v202, v204
    v_add_f32 v203, v203, v205
    s_mov_b64 exec, 0xffff
    buffer_store_dwordx2 v[202:203], v8, s[8:11], s47 offen sc1
    s_mov_b64 exec, -1
    s_lshl_b32 s40, s35, 8
    s_lshl_b32 s41, s36, 2
    s_add_u32 s40, s40, s41
    s_add_u32 s40, s40, s26
    s_add_u32 s40, s40, 16384
    v_mov_b32 v6, 1
    v_mov_b32 v7, 0
    s_waitcnt vmcnt(0)
    s_barrier
    s_cmp_lg_u32 s3, 0
    s_cbranch_scc1 LSG_9
    s_mov_b64 exec, 1
    buffer_store_dword v6, v7, s[8:11], s40 offen sc1
    s_mov_b64 exec, -1
LSG_9:
    s_mul_i32 s30, s17, 98304
    s_add_u32 s30, s30, 0x0
    s_mul_i32 s31, s3, 3072
    s_add_u32 s30, s30, s31
    s_mov_b32 m0, s31
    s_add_u32 s31, s31, 12288
    buffer_load_dwordx4 v1, s[8:11], s30 offen offset:0 lds
    buffer_load_dwordx4 v1, s[8:11], s30 offen offset:1024 lds
    buffer_load_dwordx4 v1, s[8:11], s30 offen offset:2048 lds
    s_add_u32 s30, s30, 12288
    s_mov_b32 m0, s31
    s_add_u32 s31, s31, 12288
    buffer_load_dwordx4 v1, s[8:11], s30 offen offset:0 lds
    buffer_load_dwordx4 v1, s[8:11], s30 offen offset:1024 lds
    buffer_load_dwordx4 v1, s[8:11], s30 offen offset:2048 lds
    s_add_u32 s30, s30, 12288
    s_mov_b32 m0, s31
    s_add_u32 s31, s31, 12288
    buffer_load_dwordx4 v1, s[8:11], s30 offen offset:0 lds
    buffer_load_dwordx4 v1, s[8:11], s30 offen offset:1024 lds
    buffer_load_dwordx4 v1, s[8:11], s30 offen offset:2048 lds
    s_add_u32 s30, s30, 12288
    s_mov_b32 m0, s31
    s_add_u32 s31, s31, 12288
    buffer_load_dwordx4 v1, s[8:11], s30 offen offset:0 lds
    buffer_load_dwordx4 v1, s[8:11], s30 offen offset:1024 lds
    buffer_load_dwordx4 v1, s[8:11], s30 offen offset:2048 lds
    s_add_u32 s30, s30, 12288
    s_mov_b32 m0, s31
    s_add_u32 s31, s31, 12288
    buffer_load_dwordx4 v1, s[8:11], s30 offen offset:0 lds
    buffer_load_dwordx4 v1, s[8:11], s30 offen offset:1024 lds
    buffer_load_dwordx4 v1, s[8:11], s30 offen offset:2048 lds
    s_add_u32 s30, s30, 12288
    s_mov_b32 m0, s31
    s_add_u32 s31, s31, 12288
    buffer_load_dwordx4 v1, s[8:11], s30 offen offset:0 lds
    buffer_load_dwordx4 v1, s[8:11], s30 offen offset:1024 lds
    buffer_load_dwordx4 v1, s[8:11], s30 offen offset:2048 lds
    s_add_u32 s30, s30, 12288
    s_mov_b32 m0, s31
    s_add_u32 s31, s31, 12288
    buffer_load_dwordx4 v1, s[8:11], s30 offen offset:0 lds
    buffer_load_dwordx4 v1, s[8:11], s30 offen offset:1024 lds
    buffer_load_dwordx4 v1, s[8:11], s30 offen offset:2048 lds
    s_add_u32 s30, s30, 12288
    s_mov_b32 m0, s31
    s_add_u32 s31, s31, 12288
    buffer_load_dwordx4 v1, s[8:11], s30 offen offset:0 lds
    buffer_load_dwordx4 v1, s[8:11], s30 offen offset:1024 lds
    buffer_load_dwordx4 v1, s[8:11], s30 offen offset:2048 lds
    s_add_u32 s30, s30, 12288
    s_mov_b32 s25, 1
    s_mov_b32 s24, 0x1400000
    s_mov_b32 s26, 0x935000
    s_branch LM_layer
LM_final:
    v_lshlrev_b32 v6, 10, v3
    v_lshl_add_u32 v6, v4, 3, v6
    s_lshl_b32 s30, s20, 2
    s_add_u32 s30, s30, s3
    s_lshl_b32 s30, s30, 14
    s_lshl_b32 s31, s21, 7
    s_add_u32 s30, s30, s31
    buffer_store_dwordx2 v[248:249], v6, s[12:15], s30 offen offset:0
    buffer_store_dwordx2 v[250:251], v6, s[12:15], s30 offen offset:32
    buffer_store_dwordx2 v[252:253], v6, s[12:15], s30 offen offset:64
    buffer_store_dwordx2 v[254:255], v6, s[12:15], s30 offen offset:96
LM_end:
    s_endpgm
.section .rodata,"a"
.p2align 6
.amdhsa_kernel prep_kernel
  .amdhsa_next_free_vgpr 56
  .amdhsa_next_free_sgpr 80
  .amdhsa_accum_offset 56
  .amdhsa_group_segment_fixed_size 0
  .amdhsa_kernarg_size 80
  .amdhsa_user_sgpr_count 2
  .amdhsa_user_sgpr_kernarg_segment_ptr 1
  .amdhsa_system_sgpr_workgroup_id_x 1
.end_amdhsa_kernel
.p2align 6
.amdhsa_kernel main_kernel
  .amdhsa_next_free_vgpr 512
  .amdhsa_next_free_sgpr 100
  .amdhsa_accum_offset 256
  .amdhsa_group_segment_fixed_size 0
  .amdhsa_kernarg_size 80
  .amdhsa_user_sgpr_count 2
  .amdhsa_user_sgpr_kernarg_segment_ptr 1
  .amdhsa_system_sgpr_workgroup_id_x 1
.end_amdhsa_kernel
```
